```python
import torch

def _softmax(x, axis=-1):
    return torch.softmax(x, dim=axis)
def _gelu(x):
    return torch.nn.functional.gelu(x, approximate="tanh")
def _silu(x):
    return torch.nn.functional.silu(x)
def _sigmoid(x):
    return torch.sigmoid(x)
def _layernorm(x, axis=-1, eps=1e-5):
    m = x.mean(dim=axis, keepdim=True)
    v = x.var(dim=axis, keepdim=True, unbiased=False)
    return (x - m) / torch.sqrt(v + eps)
def _scatter_add(tgt, idx, src, axis=0):
    return tgt.clone().index_add_(axis, idx, src)
def _segment_sum(src, seg, n):
    out = torch.zeros((n,) + src.shape[1:], dtype=src.dtype)
    return out.index_add_(0, seg, src)
def _pad(x, pw):
    flat = tuple(v for pair in reversed(pw) for v in pair)
    return torch.nn.functional.pad(x, flat)

kernel_name = 'gated_mix__linear_kernel_hedgehog__glu_gated_swiglu__prompt'

def setup_inputs():

    _w = (lambda a: (lambda t: t.to(torch.bfloat16) if t.is_floating_point() else t)(torch.as_tensor(a)))
    def _A_setup():
        B, S, D, H = 1, 2048, 512, 32
        Dh = D // H
        return {
            "x": _w((lambda *s: torch.randn(*s, dtype=torch.bfloat16) * 0.05)(B, S, D)),
            "wqkv": _w((lambda *s: torch.randn(*s, dtype=torch.bfloat16) * 0.8)(D, 3 * D)),
            "w_phi": _w((lambda *s: torch.randn(*s, dtype=torch.bfloat16) * 0.8)(H, Dh, Dh) * (Dh ** -0.5)),
            "wo": _w((lambda *s: torch.randn(*s, dtype=torch.bfloat16) * 0.05)(D, D)),
        }
    _A_in = _A_setup()

    def _B_setup():
        B, S, D, F = 1, 2048, 512, 1792
        return {
            "x": _w((lambda *s: torch.randn(*s, dtype=torch.bfloat16) * 0.05)(B, S, D)),
            "w1": _w((lambda *s: torch.randn(*s, dtype=torch.bfloat16) * 1.6)(D, F) * (2.0 / D) ** 0.5),
            "w3": _w((lambda *s: torch.randn(*s, dtype=torch.bfloat16) * 1.6)(D, F) * (2.0 / D) ** 0.5),
            "w2": _w((lambda *s: torch.randn(*s, dtype=torch.bfloat16) * 1.6)(F, D) * (2.0 / F) ** 0.5),
        }
    _B_in = _B_setup()

    return {
        "A_x": _A_in["x"],
        "A_wqkv": _A_in["wqkv"],
        "A_w_phi": _A_in["w_phi"],
        "A_wo": _A_in["wo"],
        "B_x": _B_in["x"],
        "B_w1": _B_in["w1"],
        "B_w3": _B_in["w3"],
        "B_w2": _B_in["w2"],
        "gate_w": _w((lambda *s: torch.randn(*s, dtype=torch.bfloat16) * 0.05)(512) * 16.0),
    }

def reference(A_x, A_wqkv, A_w_phi, A_wo, B_x, B_w1, B_w3, B_w2, gate_w):
    def _A_ref(x, wqkv, w_phi, wo):
        B, S, D = x.shape
        H = 32; Dh = D // H
        qkv = (lambda x, *d: x.permute(*d))((x @ wqkv).reshape(B, S, 3, H, Dh), 2, 0, 3, 1, 4)
        q, k, v = qkv[0], qkv[1], qkv[2]
        pq = torch.einsum("bhsd,hdf->bhsf", q, w_phi)
        pk = torch.einsum("bhsd,hdf->bhsf", k, w_phi)
        phi_q = torch.concatenate([_softmax(pq, axis=-1), _softmax(-pq, axis=-1)], axis=-1)
        phi_k = torch.concatenate([_softmax(pk, axis=-1), _softmax(-pk, axis=-1)], axis=-1)
        kv = torch.einsum("bhsf,bhsd->bhfd", phi_k, v)
        z  = torch.einsum("bhsf->bhf", phi_k)
        num = torch.einsum("bhqf,bhfd->bhqd", phi_q, kv)
        den = torch.einsum("bhqf,bhf->bhq", phi_q, z)[..., None] + 1e-6
        o = num / den
        return (lambda x, *d: x.permute(*d))(o, 0, 2, 1, 3).reshape(B, S, D) @ wo

    def _B_ref(x, w1, w3, w2):
        gate = torch.einsum("bsd,df->bsf", x, w1)
        up = torch.einsum("bsd,df->bsf", x, w3)
        h = _silu(gate) * up
        out = torch.einsum("bsf,fd->bsd", h, w2)
        return out

    x = A_x
    g = _sigmoid((x * gate_w).sum(-1, keepdims=True))
    a = _A_ref(x, A_wqkv, A_w_phi, A_wo)
    b = _B_ref(x, B_w1, B_w3, B_w2)
    return g * a + (1 - g) * b
```

```asm
; @launch grid=(256,1,1) block=(512,1,1) lds=163840
.amdgcn_target "amdgcn-amd-amdhsa--gfx950"
.text
.globl gated_mix__linear_kernel_hedgehog__glu_gated_swiglu__prompt_kernel
.p2align 8
.type gated_mix__linear_kernel_hedgehog__glu_gated_swiglu__prompt_kernel,@function
gated_mix__linear_kernel_hedgehog__glu_gated_swiglu__prompt_kernel:
s_cmp_ge_u32 s2, 0x100
s_cbranch_scc1 L_end
s_load_dwordx2 s[12:13], s[0:1], 0
s_load_dwordx2 s[16:17], s[0:1], 8
s_load_dwordx2 s[36:37], s[0:1], 16
s_load_dwordx2 s[32:33], s[0:1], 24
s_load_dwordx2 s[20:21], s[0:1], 40
s_load_dwordx2 s[24:25], s[0:1], 48
s_load_dwordx2 s[28:29], s[0:1], 56
s_load_dwordx2 s[40:41], s[0:1], 64
s_load_dwordx2 s[48:49], s[0:1], 72
s_load_dwordx2 s[52:53], s[0:1], 80
s_load_dwordx2 s[44:45], s[0:1], 88
v_readfirstlane_b32 s4, v0
s_mov_b32 s14, 0x200000
s_mov_b32 s15, 0x20000
s_mov_b32 s18, 0x180000
s_mov_b32 s19, 0x20000
s_mov_b32 s38, 0x4000
s_mov_b32 s39, 0x20000
s_mov_b32 s34, 0x80000
s_mov_b32 s35, 0x20000
s_mov_b32 s22, 0x1c0000
s_mov_b32 s23, 0x20000
s_mov_b32 s26, 0x1c0000
s_mov_b32 s27, 0x20000
s_mov_b32 s30, 0x1c0000
s_mov_b32 s31, 0x20000
s_mov_b32 s42, 0x400
s_mov_b32 s43, 0x20000
s_mov_b32 s50, 0x200000
s_mov_b32 s51, 0x20000
s_mov_b32 s54, 0x100
s_mov_b32 s55, 0x20000
s_mov_b32 s46, 0x10000000
s_mov_b32 s47, 0x20000
s_and_b32 s10, s2, 7
s_lshr_b32 s11, s2, 3
s_and_b32 s5, s10, 3
s_lshl_b32 s5, s5, 2
s_and_b32 s9, s11, 3
s_add_u32 s5, s5, s9
s_lshr_b32 s6, s10, 2
s_lshl_b32 s6, s6, 3
s_lshr_b32 s9, s11, 2
s_add_u32 s6, s6, s9
s_lshl_b32 s7, s10, 2
s_lshr_b32 s9, s11, 3
s_add_u32 s7, s7, s9
s_and_b32 s8, s11, 7
s_add_u32 s60, s5, s6
s_and_b32 s60, s60, 3
s_mov_b32 s56, 0x3fb8aa3b
s_mov_b32 s57, 0xbfb8aa3b
s_mov_b32 s3, 0x78
s_lshr_b32 s9, s4, 6
s_and_b32 s4, s9, 3
v_and_b32 v0, 63, v0
s_cmp_ge_u32 s9, 4
s_cbranch_scc1 L_B
L_A:
v_lshrrev_b32 v12, 4, v0
v_and_b32 v13, 7, v0
v_xor_b32 v12, v12, v13
v_lshlrev_b32 v12, 4, v12
v_lshrrev_b32 v13, 3, v0
v_lshlrev_b32 v13, 10, v13
v_add_u32 v64, v12, v13
v_xor_b32 v65, 64, v64
v_add_u32 v66, 0x3800, v64
v_add_u32 v65, 0x1c00, v65
v_add_u32 v67, 0x3800, v65
s_lshl_b32 s66, s5, 7
s_lshl_b32 s9, s4, 5
s_add_u32 s66, s66, s9
s_lshl_b32 s66, s66, 10
s_add_u32 s71, s60, 0
s_and_b32 s71, s71, 3
s_lshl_b32 s71, s71, 8
s_add_u32 s71, s71, s66
s_add_u32 s72, s60, 1
s_and_b32 s72, s72, 3
s_lshl_b32 s72, s72, 8
s_add_u32 s72, s72, s66
s_lshl_b32 s9, s4, 13
s_add_u32 s62, s9, 0x14000
s_add_u32 s63, s9, 0x1c000
s_add_u32 s10, s9, 0xc000
s_cmp_ge_u32 s4, 2
s_cselect_b32 s63, s10, s63
s_waitcnt lgkmcnt(0)
s_add_u32 m0, s62, 0
s_add_u32 s10, s71, 0
buffer_load_dwordx4 v64, s[12:15], s10 offen lds
buffer_load_dwordx4 v65, s[12:15], s10 offen offset:1024 lds
buffer_load_dwordx4 v66, s[12:15], s10 offen offset:2048 lds
buffer_load_dwordx4 v67, s[12:15], s10 offen offset:3072 lds
s_add_u32 m0, s62, 0x1000
s_add_u32 s11, s71, 0x80
buffer_load_dwordx4 v64, s[12:15], s11 offen lds
buffer_load_dwordx4 v65, s[12:15], s11 offen offset:1024 lds
buffer_load_dwordx4 v66, s[12:15], s11 offen offset:2048 lds
buffer_load_dwordx4 v67, s[12:15], s11 offen offset:3072 lds
s_lshl_b32 s9, s4, 13
s_add_u32 s64, s9, 0
s_add_u32 s65, s9, 0x8000
v_bfe_u32 v12, v0, 1, 3
v_lshrrev_b32 v13, 5, v0
v_xor_b32 v12, v12, v13
v_lshlrev_b32 v12, 4, v12
v_and_b32 v13, 7, v0
v_lshlrev_b32 v13, 7, v13
v_add_u32 v12, v12, v13
v_bfe_u32 v13, v0, 3, 2
v_lshlrev_b32 v13, 10, v13
v_add_u32 v8, v12, v13
v_lshrrev_b32 v12, 5, v0
v_bfe_u32 v13, v0, 4, 1
v_xor_b32 v13, v13, v12
v_lshlrev_b32 v13, 5, v13
v_lshlrev_b32 v12, 9, v12
v_add_u32 v12, v12, v13
v_bfe_u32 v13, v0, 2, 2
v_lshlrev_b32 v13, 6, v13
v_add_u32 v12, v12, v13
v_and_b32 v13, 3, v0
v_lshlrev_b32 v13, 3, v13
v_add_u32 v12, v12, v13
v_add_u32 v3, 0x14000, v12
v_add_u32 v4, 0x10000, v3
v_bfe_u32 v12, v0, 4, 1
v_lshlrev_b32 v12, 10, v12
v_and_b32 v13, 15, v0
v_lshlrev_b32 v13, 4, v13
v_add_u32 v12, v12, v13
v_lshrrev_b32 v13, 5, v0
v_lshlrev_b32 v13, 8, v13
v_add_u32 v1, v12, v13
s_lshl_b32 s9, s4, 11
s_add_u32 s9, s9, 0x10000
v_lshlrev_b32 v12, 4, v0
v_add_u32 v2, s9, v12
v_cmp_eq_u32 vcc, 0, v0
v_mov_b32 v7, 0x7ffffff0
s_nop 0
v_cndmask_b32 v7, v7, 0, vcc
s_lshr_b32 s9, s4, 1
s_lshl_b32 s10, s5, 1
s_add_u32 s10, s10, s9
s_mul_i32 s67, s10, 0x48
s_lshr_b32 s11, s6, 2
s_mul_i32 s11, s11, 18
s_add_u32 s67, s67, s11
s_lshl_b32 s67, s67, 12
s_add_u32 s67, s67, 0x200000
s_and_b32 s11, s6, 3
s_lshr_b32 s10, s11, 1
s_add_u32 s10, s10, 16
s_lshl_b32 s10, s10, 12
s_add_u32 s68, s67, s10
s_and_b32 s10, s6, 1
s_lshl_b32 s10, s10, 9
s_add_u32 s68, s68, s10
s_and_b32 s10, s4, 1
s_lshl_b32 s10, s10, 11
s_add_u32 s68, s68, s10
s_lshl_b32 s11, s11, 12
s_add_u32 s67, s67, s11
s_add_u32 s67, s67, s10
s_lshl_b32 s69, s5, 2
s_lshr_b32 s10, s6, 2
s_add_u32 s69, s69, s10
s_lshl_b32 s69, s69, 1
s_add_u32 s69, s69, s9
s_lshl_b32 s69, s69, 8
s_add_u32 s69, s69, 0
s_lshl_b32 s70, s4, 7
s_add_u32 s70, s70, 0x13800
s_lshl_b32 s9, s60, 1
s_add_u32 s9, s9, s4
s_lshl_b32 s9, s9, 1
s_and_b32 s36, s9, 15
s_xor_b32 s37, s36, 8
s_mul_i32 s9, s6, 0x50000
s_add_u32 s9, s9, 0xfec000
s_lshl_b32 s36, s36, 11
s_add_u32 s36, s36, s9
s_lshl_b32 s37, s37, 11
s_add_u32 s37, s37, s9
s_lshl_b32 s38, s4, 12
s_add_u32 s38, s38, 0x14000
s_add_u32 s28, s60, 0
s_and_b32 s28, s28, 3
s_lshl_b32 s28, s28, 8
s_add_u32 s29, s60, 1
s_and_b32 s29, s29, 3
s_lshl_b32 s29, s29, 8
s_add_u32 s30, s60, 2
s_and_b32 s30, s30, 3
s_lshl_b32 s30, s30, 8
s_add_u32 s31, s60, 3
s_and_b32 s31, s31, 3
s_lshl_b32 s31, s31, 8
s_setprio 1
s_add_u32 m0, s63, 0
s_add_u32 s10, s72, 0
buffer_load_dwordx4 v64, s[12:15], s10 offen lds
buffer_load_dwordx4 v65, s[12:15], s10 offen offset:1024 lds
buffer_load_dwordx4 v66, s[12:15], s10 offen offset:2048 lds
buffer_load_dwordx4 v67, s[12:15], s10 offen offset:3072 lds
s_add_u32 m0, s63, 0x1000
s_add_u32 s11, s72, 0x80
buffer_load_dwordx4 v64, s[12:15], s11 offen lds
buffer_load_dwordx4 v65, s[12:15], s11 offen offset:1024 lds
buffer_load_dwordx4 v66, s[12:15], s11 offen offset:2048 lds
buffer_load_dwordx4 v67, s[12:15], s11 offen offset:3072 lds
v_add_u32 v9, s62, v8
v_xor_b32 v10, 32, v9
v_xor_b32 v5, 64, v9
v_xor_b32 v6, 0x60, v9
s_waitcnt vmcnt(8)
ds_read_b128 v[128:131], v9
ds_read_b128 v[132:135], v10
ds_read_b128 v[136:139], v5
ds_read_b128 v[140:143], v6
ds_read_b128 v[144:147], v9 offset:4096
ds_read_b128 v[148:151], v10 offset:4096
ds_read_b128 v[152:155], v5 offset:4096
ds_read_b128 v[156:159], v6 offset:4096
s_waitcnt lgkmcnt(0)
s_barrier
ds_read_b64_tr_b16 v[32:33], v3 offset:49152
ds_read_b64_tr_b16 v[34:35], v3 offset:49408
ds_read_b64_tr_b16 v[36:37], v3 offset:50176
ds_read_b64_tr_b16 v[38:39], v3 offset:50432
ds_read_b64_tr_b16 v[40:41], v3 offset:51200
ds_read_b64_tr_b16 v[42:43], v3 offset:51456
ds_read_b64_tr_b16 v[44:45], v3 offset:52224
ds_read_b64_tr_b16 v[46:47], v3 offset:52480
ds_read_b64_tr_b16 v[48:49], v3 offset:53248
ds_read_b64_tr_b16 v[50:51], v3 offset:53504
ds_read_b64_tr_b16 v[52:53], v3 offset:54272
ds_read_b64_tr_b16 v[54:55], v3 offset:54528
s_waitcnt lgkmcnt(8)
v_mfma_f32_32x32x16_bf16 v[64:79], v[32:35], v[128:131], 0
ds_read_b64_tr_b16 v[56:57], v3 offset:55296
ds_read_b64_tr_b16 v[58:59], v3 offset:55552
v_mfma_f32_32x32x16_bf16 v[64:79], v[36:39], v[132:135], v[64:79]
ds_read_b64_tr_b16 v[60:61], v3 offset:56320
ds_read_b64_tr_b16 v[62:63], v3 offset:56576
s_waitcnt lgkmcnt(8)
v_mfma_f32_32x32x16_bf16 v[64:79], v[40:43], v[136:139], v[64:79]
ds_read_b64_tr_b16 v[32:33], v3 offset:57344
ds_read_b64_tr_b16 v[34:35], v3 offset:57600
v_mfma_f32_32x32x16_bf16 v[64:79], v[44:47], v[140:143], v[64:79]
ds_read_b64_tr_b16 v[36:37], v3 offset:58368
ds_read_b64_tr_b16 v[38:39], v3 offset:58624
s_waitcnt lgkmcnt(8)
v_mfma_f32_32x32x16_bf16 v[64:79], v[48:51], v[144:147], v[64:79]
ds_read_b64_tr_b16 v[40:41], v3 offset:59392
ds_read_b64_tr_b16 v[42:43], v3 offset:59648
v_mfma_f32_32x32x16_bf16 v[64:79], v[52:55], v[148:151], v[64:79]
ds_read_b64_tr_b16 v[44:45], v3 offset:60416
ds_read_b64_tr_b16 v[46:47], v3 offset:60672
s_waitcnt lgkmcnt(8)
v_mfma_f32_32x32x16_bf16 v[64:79], v[56:59], v[152:155], v[64:79]
ds_read_b64_tr_b16 v[48:49], v3 offset:61440
ds_read_b64_tr_b16 v[50:51], v3 offset:61696
v_mfma_f32_32x32x16_bf16 v[64:79], v[60:63], v[156:159], v[64:79]
ds_read_b64_tr_b16 v[52:53], v3 offset:62464
ds_read_b64_tr_b16 v[54:55], v3 offset:62720
v_add_u32 v9, s63, v8
v_xor_b32 v10, 32, v9
v_xor_b32 v5, 64, v9
v_xor_b32 v6, 0x60, v9
s_waitcnt vmcnt(0)
ds_read_b128 v[160:163], v9
ds_read_b128 v[164:167], v10
ds_read_b128 v[168:171], v5
ds_read_b128 v[172:175], v6
ds_read_b128 v[176:179], v9 offset:4096
ds_read_b128 v[180:183], v10 offset:4096
ds_read_b128 v[184:187], v5 offset:4096
ds_read_b128 v[188:191], v6 offset:4096
s_waitcnt lgkmcnt(15)
s_waitcnt lgkmcnt(7)
v_mfma_f32_32x32x16_bf16 v[64:79], v[32:35], v[160:163], v[64:79]
ds_read_b64_tr_b16 v[56:57], v3 offset:63488
ds_read_b64_tr_b16 v[58:59], v3 offset:63744
s_waitcnt lgkmcnt(8)
v_mfma_f32_32x32x16_bf16 v[64:79], v[36:39], v[164:167], v[64:79]
ds_read_b64_tr_b16 v[60:61], v3 offset:64512
ds_read_b64_tr_b16 v[62:63], v3 offset:64768
s_waitcnt lgkmcnt(0)
s_barrier
v_mfma_f32_32x32x16_bf16 v[64:79], v[40:43], v[168:171], v[64:79]
ds_read_b64_tr_b16 v[32:33], v4
ds_read_b64_tr_b16 v[34:35], v4 offset:256
v_mfma_f32_32x32x16_bf16 v[64:79], v[44:47], v[172:175], v[64:79]
ds_read_b64_tr_b16 v[36:37], v4 offset:1024
ds_read_b64_tr_b16 v[38:39], v4 offset:1280
v_mfma_f32_32x32x16_bf16 v[64:79], v[48:51], v[176:179], v[64:79]
ds_read_b64_tr_b16 v[40:41], v4 offset:2048
ds_read_b64_tr_b16 v[42:43], v4 offset:2304
v_mfma_f32_32x32x16_bf16 v[64:79], v[52:55], v[180:183], v[64:79]
ds_read_b64_tr_b16 v[44:45], v4 offset:3072
ds_read_b64_tr_b16 v[46:47], v4 offset:3328
v_mfma_f32_32x32x16_bf16 v[64:79], v[56:59], v[184:187], v[64:79]
ds_read_b64_tr_b16 v[48:49], v4 offset:4096
ds_read_b64_tr_b16 v[50:51], v4 offset:4352
v_mfma_f32_32x32x16_bf16 v[64:79], v[60:63], v[188:191], v[64:79]
ds_read_b64_tr_b16 v[52:53], v4 offset:5120
ds_read_b64_tr_b16 v[54:55], v4 offset:5376
v_add_u32 v9, s64, v8
v_xor_b32 v10, 32, v9
v_xor_b32 v5, 64, v9
v_xor_b32 v6, 0x60, v9
ds_read_b128 v[192:195], v9
ds_read_b128 v[196:199], v10
ds_read_b128 v[200:203], v5
ds_read_b128 v[204:207], v6
ds_read_b128 v[208:211], v9 offset:4096
ds_read_b128 v[212:215], v10 offset:4096
ds_read_b128 v[216:219], v5 offset:4096
ds_read_b128 v[220:223], v6 offset:4096
s_waitcnt lgkmcnt(15)
s_waitcnt lgkmcnt(7)
v_mfma_f32_32x32x16_bf16 v[64:79], v[32:35], v[192:195], v[64:79]
ds_read_b64_tr_b16 v[56:57], v4 offset:6144
ds_read_b64_tr_b16 v[58:59], v4 offset:6400
s_waitcnt lgkmcnt(8)
v_mfma_f32_32x32x16_bf16 v[64:79], v[36:39], v[196:199], v[64:79]
ds_read_b64_tr_b16 v[60:61], v4 offset:7168
ds_read_b64_tr_b16 v[62:63], v4 offset:7424
s_waitcnt lgkmcnt(9)
v_mfma_f32_32x32x16_bf16 v[64:79], v[40:43], v[200:203], v[64:79]
ds_read_b64_tr_b16 v[32:33], v4 offset:8192
ds_read_b64_tr_b16 v[34:35], v4 offset:8448
s_waitcnt lgkmcnt(10)
v_mfma_f32_32x32x16_bf16 v[64:79], v[44:47], v[204:207], v[64:79]
ds_read_b64_tr_b16 v[36:37], v4 offset:9216
ds_read_b64_tr_b16 v[38:39], v4 offset:9472
s_waitcnt lgkmcnt(11)
v_mfma_f32_32x32x16_bf16 v[64:79], v[48:51], v[208:211], v[64:79]
ds_read_b64_tr_b16 v[40:41], v4 offset:10240
ds_read_b64_tr_b16 v[42:43], v4 offset:10496
s_waitcnt lgkmcnt(12)
v_mfma_f32_32x32x16_bf16 v[64:79], v[52:55], v[212:215], v[64:79]
ds_read_b64_tr_b16 v[44:45], v4 offset:11264
ds_read_b64_tr_b16 v[46:47], v4 offset:11520
s_waitcnt lgkmcnt(8)
v_mfma_f32_32x32x16_bf16 v[64:79], v[56:59], v[216:219], v[64:79]
ds_read_b64_tr_b16 v[48:49], v4 offset:12288
ds_read_b64_tr_b16 v[50:51], v4 offset:12544
v_mfma_f32_32x32x16_bf16 v[64:79], v[60:63], v[220:223], v[64:79]
ds_read_b64_tr_b16 v[52:53], v4 offset:13312
ds_read_b64_tr_b16 v[54:55], v4 offset:13568
s_barrier
v_add_u32 v9, s65, v8
v_xor_b32 v10, 32, v9
v_xor_b32 v5, 64, v9
v_xor_b32 v6, 0x60, v9
ds_read_b128 v[224:227], v9
ds_read_b128 v[228:231], v10
ds_read_b128 v[232:235], v5
ds_read_b128 v[236:239], v6
ds_read_b128 v[240:243], v9 offset:4096
ds_read_b128 v[244:247], v10 offset:4096
ds_read_b128 v[248:251], v5 offset:4096
ds_read_b128 v[252:255], v6 offset:4096
s_waitcnt lgkmcnt(15)
s_waitcnt lgkmcnt(7)
v_mfma_f32_32x32x16_bf16 v[64:79], v[32:35], v[224:227], v[64:79]
ds_read_b64_tr_b16 v[56:57], v4 offset:14336
ds_read_b64_tr_b16 v[58:59], v4 offset:14592
s_waitcnt lgkmcnt(8)
v_mfma_f32_32x32x16_bf16 v[64:79], v[36:39], v[228:231], v[64:79]
ds_read_b64_tr_b16 v[60:61], v4 offset:15360
ds_read_b64_tr_b16 v[62:63], v4 offset:15616
s_waitcnt lgkmcnt(0)
s_barrier
v_mfma_f32_32x32x16_bf16 v[64:79], v[40:43], v[232:235], v[64:79]
ds_read_b64_tr_b16 v[32:33], v3
ds_read_b64_tr_b16 v[34:35], v3 offset:256
v_mfma_f32_32x32x16_bf16 v[64:79], v[44:47], v[236:239], v[64:79]
ds_read_b64_tr_b16 v[36:37], v3 offset:1024
v_lshlrev_b32 v5, 4, v0
ds_read_b64_tr_b16 v[38:39], v3 offset:1280
v_mfma_f32_32x32x16_bf16 v[64:79], v[48:51], v[240:243], v[64:79]
ds_read_b64_tr_b16 v[40:41], v3 offset:2048
v_add_u32 v5, 0x14000, v5
ds_read_b64_tr_b16 v[42:43], v3 offset:2304
v_mfma_f32_32x32x16_bf16 v[64:79], v[52:55], v[244:247], v[64:79]
ds_read_b64_tr_b16 v[44:45], v3 offset:3072
v_add_u32 v6, 0x10000, v5
ds_read_b64_tr_b16 v[46:47], v3 offset:3328
v_mfma_f32_32x32x16_bf16 v[64:79], v[56:59], v[248:251], v[64:79]
ds_read_b64_tr_b16 v[48:49], v3 offset:4096
ds_read_b64_tr_b16 v[50:51], v3 offset:4352
v_mfma_f32_32x32x16_bf16 v[64:79], v[60:63], v[252:255], v[64:79]
ds_read_b64_tr_b16 v[52:53], v3 offset:5120
ds_read_b64_tr_b16 v[54:55], v3 offset:5376
s_waitcnt lgkmcnt(8)
v_mfma_f32_32x32x16_bf16 v[80:95], v[128:131], v[32:35], 0
ds_read_b64_tr_b16 v[56:57], v3 offset:6144
ds_read_b64_tr_b16 v[58:59], v3 offset:6400
v_mfma_f32_32x32x16_bf16 v[80:95], v[132:135], v[36:39], v[80:95]
ds_read_b64_tr_b16 v[60:61], v3 offset:7168
s_nop 3
v_cvt_pk_bf16_f32 v64, v64, v65
ds_read_b64_tr_b16 v[62:63], v3 offset:7424
s_waitcnt lgkmcnt(8)
v_mfma_f32_32x32x16_bf16 v[80:95], v[136:139], v[40:43], v[80:95]
ds_read_b64_tr_b16 v[32:33], v3 offset:8192
v_cvt_pk_bf16_f32 v65, v66, v67
ds_read_b64_tr_b16 v[34:35], v3 offset:8448
v_cvt_pk_bf16_f32 v66, v68, v69
v_mfma_f32_32x32x16_bf16 v[80:95], v[140:143], v[44:47], v[80:95]
ds_read_b64_tr_b16 v[36:37], v3 offset:9216
v_cvt_pk_bf16_f32 v67, v70, v71
ds_read_b64_tr_b16 v[38:39], v3 offset:9472
ds_write_b128 v2, v[64:67]
s_waitcnt lgkmcnt(9)
v_mfma_f32_32x32x16_bf16 v[80:95], v[144:147], v[48:51], v[80:95]
ds_read_b64_tr_b16 v[40:41], v3 offset:10240
v_cvt_pk_bf16_f32 v72, v72, v73
ds_read_b64_tr_b16 v[42:43], v3 offset:10496
v_mfma_f32_32x32x16_bf16 v[80:95], v[148:151], v[52:55], v[80:95]
ds_read_b64_tr_b16 v[44:45], v3 offset:11264
v_cvt_pk_bf16_f32 v73, v74, v75
ds_read_b64_tr_b16 v[46:47], v3 offset:11520
v_cvt_pk_bf16_f32 v74, v76, v77
s_waitcnt lgkmcnt(9)
v_mfma_f32_32x32x16_bf16 v[80:95], v[152:155], v[56:59], v[80:95]
ds_read_b64_tr_b16 v[48:49], v3 offset:12288
v_cvt_pk_bf16_f32 v75, v78, v79
ds_read_b64_tr_b16 v[50:51], v3 offset:12544
ds_write_b128 v2, v[72:75] offset:1024
v_mfma_f32_32x32x16_bf16 v[80:95], v[156:159], v[60:63], v[80:95]
ds_read_b64_tr_b16 v[52:53], v3 offset:13312
ds_read_b64_tr_b16 v[54:55], v3 offset:13568
s_waitcnt lgkmcnt(10)
v_mfma_f32_32x32x16_bf16 v[80:95], v[160:163], v[32:35], v[80:95]
ds_read_b64_tr_b16 v[56:57], v3 offset:14336
v_lshrrev_b32 v12, 5, v0
ds_read_b64_tr_b16 v[58:59], v3 offset:14592
v_lshlrev_b32 v12, 4, v12
v_mfma_f32_32x32x16_bf16 v[80:95], v[164:167], v[36:39], v[80:95]
ds_read_b64_tr_b16 v[60:61], v3 offset:15360
v_add_u32 v12, 0x13000, v12
ds_read_b64_tr_b16 v[62:63], v3 offset:15616
v_lshrrev_b32 v13, 2, v0
s_waitcnt lgkmcnt(6)
s_barrier
v_mfma_f32_32x32x16_bf16 v[80:95], v[168:171], v[40:43], v[80:95]
ds_read_b64_tr_b16 v[32:33], v3 offset:16384
v_xor_b32 v13, v13, v0
ds_read_b64_tr_b16 v[34:35], v3 offset:16640
v_and_b32 v13, 4, v13
v_mfma_f32_32x32x16_bf16 v[80:95], v[172:175], v[44:47], v[80:95]
ds_read_b64_tr_b16 v[36:37], v3 offset:17408
v_and_b32 v14, 3, v0
ds_read_b64_tr_b16 v[38:39], v3 offset:17664
v_lshrrev_b32 v13, 2, v13
s_waitcnt lgkmcnt(8)
v_mfma_f32_32x32x16_bf16 v[80:95], v[176:179], v[48:51], v[80:95]
ds_read_b64_tr_b16 v[40:41], v3 offset:18432
v_or_b32 v13, v13, v14
ds_read_b64_tr_b16 v[42:43], v3 offset:18688
v_cmp_eq_u32 vcc, 0, v13
v_mfma_f32_32x32x16_bf16 v[80:95], v[180:183], v[52:55], v[80:95]
ds_read_b64_tr_b16 v[44:45], v3 offset:19456
v_mov_b32 v10, 0x13400
ds_read_b64_tr_b16 v[46:47], v3 offset:19712
v_cndmask_b32 v10, v10, v12, vcc
s_waitcnt lgkmcnt(8)
v_mfma_f32_32x32x16_bf16 v[80:95], v[184:187], v[56:59], v[80:95]
ds_read_b64_tr_b16 v[48:49], v3 offset:20480
ds_read_b64_tr_b16 v[50:51], v3 offset:20736
v_mfma_f32_32x32x16_bf16 v[80:95], v[188:191], v[60:63], v[80:95]
ds_read_b64_tr_b16 v[52:53], v3 offset:21504
ds_read_b64_tr_b16 v[54:55], v3 offset:21760
s_waitcnt lgkmcnt(8)
v_mfma_f32_32x32x16_bf16 v[80:95], v[192:195], v[32:35], v[80:95]
ds_read_b64_tr_b16 v[56:57], v3 offset:22528
v_add_u32 v9, s28, v10
ds_read_b64_tr_b16 v[58:59], v3 offset:22784
v_mfma_f32_32x32x16_bf16 v[80:95], v[196:199], v[36:39], v[80:95]
ds_read_b64_tr_b16 v[60:61], v3 offset:23552
ds_read_b128 v[24:27], v9
ds_read_b64_tr_b16 v[62:63], v3 offset:23808
ds_read_b128 v[28:31], v9 offset:32
s_waitcnt lgkmcnt(10)
v_mfma_f32_32x32x16_bf16 v[80:95], v[200:203], v[40:43], v[80:95]
ds_read_b64_tr_b16 v[32:33], v3 offset:24576
ds_read_b64_tr_b16 v[34:35], v3 offset:24832
v_mfma_f32_32x32x16_bf16 v[80:95], v[204:207], v[44:47], v[80:95]
ds_read_b64_tr_b16 v[36:37], v3 offset:25600
ds_read_b64_tr_b16 v[38:39], v3 offset:25856
s_waitcnt lgkmcnt(10)
v_mfma_f32_32x32x16_bf16 v[80:95], v[208:211], v[48:51], v[80:95]
ds_read_b64_tr_b16 v[40:41], v3 offset:26624
ds_read_b64_tr_b16 v[42:43], v3 offset:26880
v_mfma_f32_32x32x16_bf16 v[80:95], v[212:215], v[52:55], v[80:95]
ds_read_b64_tr_b16 v[44:45], v3 offset:27648
ds_read_b64_tr_b16 v[46:47], v3 offset:27904
s_waitcnt lgkmcnt(9)
v_mfma_f32_32x32x16_bf16 v[80:95], v[216:219], v[56:59], v[80:95]
ds_read_b64_tr_b16 v[48:49], v3 offset:28672
v_mfma_f32_16x16x32_bf16 v[20:23], v[24:27], v[128:131], 0
ds_read_b64_tr_b16 v[50:51], v3 offset:28928
ds_read_b128 v[24:27], v9 offset:64
v_mfma_f32_32x32x16_bf16 v[80:95], v[220:223], v[60:63], v[80:95]
ds_read_b64_tr_b16 v[52:53], v3 offset:29696
ds_read_b64_tr_b16 v[54:55], v3 offset:29952
s_waitcnt lgkmcnt(9)
v_mfma_f32_32x32x16_bf16 v[80:95], v[224:227], v[32:35], v[80:95]
ds_read_b64_tr_b16 v[56:57], v3 offset:30720
v_mfma_f32_16x16x32_bf16 v[20:23], v[28:31], v[132:135], v[20:23]
ds_read_b64_tr_b16 v[58:59], v3 offset:30976
ds_read_b128 v[28:31], v9 offset:96
v_mfma_f32_32x32x16_bf16 v[80:95], v[228:231], v[36:39], v[80:95]
ds_read_b64_tr_b16 v[60:61], v3 offset:31744
ds_read_b64_tr_b16 v[62:63], v3 offset:32000
s_barrier
s_waitcnt lgkmcnt(10)
v_mfma_f32_32x32x16_bf16 v[80:95], v[232:235], v[40:43], v[80:95]
ds_read_b64_tr_b16 v[32:33], v3 offset:32768
s_waitcnt lgkmcnt(8)
v_mfma_f32_16x16x32_bf16 v[20:23], v[24:27], v[136:139], v[20:23]
ds_read_b64_tr_b16 v[34:35], v3 offset:33024
ds_read_b128 v[24:27], v9 offset:128
v_mfma_f32_32x32x16_bf16 v[80:95], v[236:239], v[44:47], v[80:95]
ds_read_b64_tr_b16 v[36:37], v3 offset:33792
ds_read_b64_tr_b16 v[38:39], v3 offset:34048
s_waitcnt lgkmcnt(10)
v_mfma_f32_32x32x16_bf16 v[80:95], v[240:243], v[48:51], v[80:95]
ds_read_b64_tr_b16 v[40:41], v3 offset:34816
s_waitcnt lgkmcnt(8)
v_mfma_f32_16x16x32_bf16 v[20:23], v[28:31], v[140:143], v[20:23]
ds_read_b64_tr_b16 v[42:43], v3 offset:35072
ds_read_b128 v[28:31], v9 offset:160
v_mfma_f32_32x32x16_bf16 v[80:95], v[244:247], v[52:55], v[80:95]
ds_read_b64_tr_b16 v[44:45], v3 offset:35840
ds_read_b64_tr_b16 v[46:47], v3 offset:36096
s_waitcnt lgkmcnt(10)
v_mfma_f32_32x32x16_bf16 v[80:95], v[248:251], v[56:59], v[80:95]
ds_read_b64_tr_b16 v[48:49], v3 offset:36864
s_waitcnt lgkmcnt(8)
v_mfma_f32_16x16x32_bf16 v[20:23], v[24:27], v[144:147], v[20:23]
ds_read_b64_tr_b16 v[50:51], v3 offset:37120
ds_read_b128 v[24:27], v9 offset:192
v_mfma_f32_32x32x16_bf16 v[80:95], v[252:255], v[60:63], v[80:95]
ds_read_b64_tr_b16 v[52:53], v3 offset:37888
ds_read_b64_tr_b16 v[54:55], v3 offset:38144
s_waitcnt lgkmcnt(10)
v_mfma_f32_32x32x16_bf16 v[96:111], v[32:35], v[128:131], 0
ds_read_b64_tr_b16 v[56:57], v3 offset:38912
s_waitcnt lgkmcnt(8)
v_mfma_f32_16x16x32_bf16 v[20:23], v[28:31], v[148:151], v[20:23]
ds_read_b64_tr_b16 v[58:59], v3 offset:39168
ds_read_b128 v[28:31], v9 offset:224
v_mfma_f32_32x32x16_bf16 v[96:111], v[36:39], v[132:135], v[96:111]
ds_read_b64_tr_b16 v[60:61], v3 offset:39936
s_nop 0
v_cvt_pk_bf16_f32 v80, v80, v81
ds_read_b64_tr_b16 v[62:63], v3 offset:40192
s_waitcnt lgkmcnt(10)
v_mfma_f32_32x32x16_bf16 v[96:111], v[40:43], v[136:139], v[96:111]
ds_read_b64_tr_b16 v[32:33], v3 offset:40960
s_waitcnt lgkmcnt(8)
v_mfma_f32_16x16x32_bf16 v[20:23], v[24:27], v[152:155], v[20:23]
ds_read_b64_tr_b16 v[34:35], v3 offset:41216
v_add_u32 v9, s29, v10
ds_read_b128 v[24:27], v9
v_cvt_pk_bf16_f32 v81, v82, v83
v_cvt_pk_bf16_f32 v82, v84, v85
v_mfma_f32_32x32x16_bf16 v[96:111], v[44:47], v[140:143], v[96:111]
ds_read_b64_tr_b16 v[36:37], v3 offset:41984
v_cvt_pk_bf16_f32 v83, v86, v87
ds_read_b64_tr_b16 v[38:39], v3 offset:42240
ds_write_b128 v2, v[80:83]
s_waitcnt lgkmcnt(11)
v_mfma_f32_32x32x16_bf16 v[96:111], v[48:51], v[144:147], v[96:111]
ds_read_b64_tr_b16 v[40:41], v3 offset:43008
s_waitcnt lgkmcnt(9)
v_mfma_f32_16x16x32_bf16 v[20:23], v[28:31], v[156:159], v[20:23]
ds_read_b64_tr_b16 v[42:43], v3 offset:43264
ds_read_b128 v[28:31], v9 offset:32
v_cvt_pk_bf16_f32 v88, v88, v89
v_mfma_f32_32x32x16_bf16 v[96:111], v[52:55], v[148:151], v[96:111]
ds_read_b64_tr_b16 v[44:45], v3 offset:44032
v_cvt_pk_bf16_f32 v89, v90, v91
ds_read_b64_tr_b16 v[46:47], v3 offset:44288
v_cvt_pk_bf16_f32 v90, v92, v93
s_waitcnt lgkmcnt(11)
v_mfma_f32_32x32x16_bf16 v[96:111], v[56:59], v[152:155], v[96:111]
ds_read_b64_tr_b16 v[48:49], v3 offset:45056
s_waitcnt lgkmcnt(9)
v_mfma_f32_16x16x32_bf16 v[20:23], v[24:27], v[160:163], v[20:23]
ds_read_b64_tr_b16 v[50:51], v3 offset:45312
ds_read_b128 v[24:27], v9 offset:64
v_cvt_pk_bf16_f32 v91, v94, v95
ds_write_b128 v2, v[88:91] offset:1024
v_mfma_f32_32x32x16_bf16 v[96:111], v[60:63], v[156:159], v[96:111]
ds_read_b64_tr_b16 v[52:53], v3 offset:46080
ds_read_b64_tr_b16 v[54:55], v3 offset:46336
s_waitcnt lgkmcnt(12)
v_mfma_f32_32x32x16_bf16 v[96:111], v[32:35], v[160:163], v[96:111]
ds_read_b64_tr_b16 v[56:57], v3 offset:47104
s_waitcnt lgkmcnt(9)
v_mfma_f32_16x16x32_bf16 v[20:23], v[28:31], v[164:167], v[20:23]
ds_read_b64_tr_b16 v[58:59], v3 offset:47360
ds_read_b128 v[28:31], v9 offset:96
v_mfma_f32_32x32x16_bf16 v[96:111], v[36:39], v[164:167], v[96:111]
ds_read_b64_tr_b16 v[60:61], v3 offset:48128
ds_read_b64_tr_b16 v[62:63], v3 offset:48384
s_waitcnt lgkmcnt(7)
s_barrier
v_mfma_f32_32x32x16_bf16 v[96:111], v[40:43], v[168:171], v[96:111]
ds_read_b64_tr_b16 v[32:33], v3 offset:49152
v_mfma_f32_16x16x32_bf16 v[20:23], v[24:27], v[168:171], v[20:23]
ds_read_b64_tr_b16 v[34:35], v3 offset:49408
ds_read_b128 v[24:27], v9 offset:128
v_mfma_f32_32x32x16_bf16 v[96:111], v[44:47], v[172:175], v[96:111]
ds_read_b64_tr_b16 v[36:37], v3 offset:50176
ds_read_b64_tr_b16 v[38:39], v3 offset:50432
s_waitcnt lgkmcnt(10)
v_mfma_f32_32x32x16_bf16 v[96:111], v[48:51], v[176:179], v[96:111]
ds_read_b64_tr_b16 v[40:41], v3 offset:51200
s_waitcnt lgkmcnt(8)
v_mfma_f32_16x16x32_bf16 v[20:23], v[28:31], v[172:175], v[20:23]
ds_read_b64_tr_b16 v[42:43], v3 offset:51456
ds_read_b128 v[28:31], v9 offset:160
v_mfma_f32_32x32x16_bf16 v[96:111], v[52:55], v[180:183], v[96:111]
ds_read_b64_tr_b16 v[44:45], v3 offset:52224
ds_read_b64_tr_b16 v[46:47], v3 offset:52480
s_waitcnt lgkmcnt(10)
v_mfma_f32_32x32x16_bf16 v[96:111], v[56:59], v[184:187], v[96:111]
ds_read_b64_tr_b16 v[48:49], v3 offset:53248
s_waitcnt lgkmcnt(8)
v_mfma_f32_16x16x32_bf16 v[20:23], v[24:27], v[176:179], v[20:23]
ds_read_b64_tr_b16 v[50:51], v3 offset:53504
ds_read_b128 v[24:27], v9 offset:192
v_mfma_f32_32x32x16_bf16 v[96:111], v[60:63], v[188:191], v[96:111]
ds_read_b64_tr_b16 v[52:53], v3 offset:54272
ds_read_b64_tr_b16 v[54:55], v3 offset:54528
s_waitcnt lgkmcnt(10)
v_mfma_f32_32x32x16_bf16 v[96:111], v[32:35], v[192:195], v[96:111]
ds_read_b64_tr_b16 v[56:57], v3 offset:55296
s_waitcnt lgkmcnt(8)
v_mfma_f32_16x16x32_bf16 v[20:23], v[28:31], v[180:183], v[20:23]
ds_read_b64_tr_b16 v[58:59], v3 offset:55552
ds_read_b128 v[28:31], v9 offset:224
v_mfma_f32_32x32x16_bf16 v[96:111], v[36:39], v[196:199], v[96:111]
ds_read_b64_tr_b16 v[60:61], v3 offset:56320
ds_read_b64_tr_b16 v[62:63], v3 offset:56576
s_waitcnt lgkmcnt(10)
v_mfma_f32_32x32x16_bf16 v[96:111], v[40:43], v[200:203], v[96:111]
ds_read_b64_tr_b16 v[32:33], v3 offset:57344
s_waitcnt lgkmcnt(8)
v_mfma_f32_16x16x32_bf16 v[20:23], v[24:27], v[184:187], v[20:23]
ds_read_b64_tr_b16 v[34:35], v3 offset:57600
v_add_u32 v9, s30, v10
ds_read_b128 v[24:27], v9
v_mfma_f32_32x32x16_bf16 v[96:111], v[44:47], v[204:207], v[96:111]
ds_read_b64_tr_b16 v[36:37], v3 offset:58368
ds_read_b64_tr_b16 v[38:39], v3 offset:58624
s_waitcnt lgkmcnt(10)
v_mfma_f32_32x32x16_bf16 v[96:111], v[48:51], v[208:211], v[96:111]
ds_read_b64_tr_b16 v[40:41], v3 offset:59392
s_waitcnt lgkmcnt(8)
v_mfma_f32_16x16x32_bf16 v[20:23], v[28:31], v[188:191], v[20:23]
ds_read_b64_tr_b16 v[42:43], v3 offset:59648
ds_read_b128 v[28:31], v9 offset:32
v_mfma_f32_32x32x16_bf16 v[96:111], v[52:55], v[212:215], v[96:111]
ds_read_b64_tr_b16 v[44:45], v3 offset:60416
ds_read_b64_tr_b16 v[46:47], v3 offset:60672
s_waitcnt lgkmcnt(10)
v_mfma_f32_32x32x16_bf16 v[96:111], v[56:59], v[216:219], v[96:111]
ds_read_b64_tr_b16 v[48:49], v3 offset:61440
s_waitcnt lgkmcnt(8)
v_mfma_f32_16x16x32_bf16 v[20:23], v[24:27], v[192:195], v[20:23]
ds_read_b64_tr_b16 v[50:51], v3 offset:61696
ds_read_b128 v[24:27], v9 offset:64
v_mfma_f32_32x32x16_bf16 v[96:111], v[60:63], v[220:223], v[96:111]
ds_read_b64_tr_b16 v[52:53], v3 offset:62464
ds_read_b64_tr_b16 v[54:55], v3 offset:62720
s_waitcnt lgkmcnt(10)
v_mfma_f32_32x32x16_bf16 v[96:111], v[32:35], v[224:227], v[96:111]
ds_read_b64_tr_b16 v[56:57], v3 offset:63488
s_waitcnt lgkmcnt(8)
v_mfma_f32_16x16x32_bf16 v[20:23], v[28:31], v[196:199], v[20:23]
ds_read_b64_tr_b16 v[58:59], v3 offset:63744
ds_read_b128 v[28:31], v9 offset:96
v_mfma_f32_32x32x16_bf16 v[96:111], v[36:39], v[228:231], v[96:111]
ds_read_b64_tr_b16 v[60:61], v3 offset:64512
ds_read_b64_tr_b16 v[62:63], v3 offset:64768
s_barrier
s_waitcnt lgkmcnt(10)
v_mfma_f32_32x32x16_bf16 v[96:111], v[40:43], v[232:235], v[96:111]
ds_read_b64_tr_b16 v[32:33], v4
s_waitcnt lgkmcnt(8)
v_mfma_f32_16x16x32_bf16 v[20:23], v[24:27], v[200:203], v[20:23]
ds_read_b64_tr_b16 v[34:35], v4 offset:256
ds_read_b128 v[24:27], v9 offset:128
v_mfma_f32_32x32x16_bf16 v[96:111], v[44:47], v[236:239], v[96:111]
ds_read_b64_tr_b16 v[36:37], v4 offset:1024
ds_read_b64_tr_b16 v[38:39], v4 offset:1280
s_waitcnt lgkmcnt(10)
v_mfma_f32_32x32x16_bf16 v[96:111], v[48:51], v[240:243], v[96:111]
ds_read_b64_tr_b16 v[40:41], v4 offset:2048
s_waitcnt lgkmcnt(8)
v_mfma_f32_16x16x32_bf16 v[20:23], v[28:31], v[204:207], v[20:23]
ds_read_b64_tr_b16 v[42:43], v4 offset:2304
ds_read_b128 v[28:31], v9 offset:160
v_mfma_f32_32x32x16_bf16 v[96:111], v[52:55], v[244:247], v[96:111]
ds_read_b64_tr_b16 v[44:45], v4 offset:3072
ds_read_b64_tr_b16 v[46:47], v4 offset:3328
s_waitcnt lgkmcnt(10)
v_mfma_f32_32x32x16_bf16 v[96:111], v[56:59], v[248:251], v[96:111]
ds_read_b64_tr_b16 v[48:49], v4 offset:4096
s_waitcnt lgkmcnt(8)
v_mfma_f32_16x16x32_bf16 v[20:23], v[24:27], v[208:211], v[20:23]
ds_read_b64_tr_b16 v[50:51], v4 offset:4352
ds_read_b128 v[24:27], v9 offset:192
v_mfma_f32_32x32x16_bf16 v[96:111], v[60:63], v[252:255], v[96:111]
ds_read_b64_tr_b16 v[52:53], v4 offset:5120
ds_read_b64_tr_b16 v[54:55], v4 offset:5376
s_waitcnt lgkmcnt(10)
v_mfma_f32_32x32x16_bf16 v[112:127], v[32:35], v[128:131], 0
ds_read_b64_tr_b16 v[56:57], v4 offset:6144
s_waitcnt lgkmcnt(8)
v_mfma_f32_16x16x32_bf16 v[20:23], v[28:31], v[212:215], v[20:23]
ds_read_b64_tr_b16 v[58:59], v4 offset:6400
ds_read_b128 v[28:31], v9 offset:224
v_mfma_f32_32x32x16_bf16 v[112:127], v[36:39], v[132:135], v[112:127]
ds_read_b64_tr_b16 v[60:61], v4 offset:7168
s_nop 0
v_cvt_pk_bf16_f32 v96, v96, v97
ds_read_b64_tr_b16 v[62:63], v4 offset:7424
s_waitcnt lgkmcnt(10)
v_mfma_f32_32x32x16_bf16 v[112:127], v[40:43], v[136:139], v[112:127]
ds_read_b64_tr_b16 v[32:33], v4 offset:8192
s_waitcnt lgkmcnt(8)
v_mfma_f32_16x16x32_bf16 v[20:23], v[24:27], v[216:219], v[20:23]
ds_read_b64_tr_b16 v[34:35], v4 offset:8448
v_add_u32 v9, s31, v10
ds_read_b128 v[24:27], v9
v_cvt_pk_bf16_f32 v97, v98, v99
v_cvt_pk_bf16_f32 v98, v100, v101
v_mfma_f32_32x32x16_bf16 v[112:127], v[44:47], v[140:143], v[112:127]
ds_read_b64_tr_b16 v[36:37], v4 offset:9216
v_cvt_pk_bf16_f32 v99, v102, v103
ds_read_b64_tr_b16 v[38:39], v4 offset:9472
ds_write_b128 v2, v[96:99]
s_waitcnt lgkmcnt(11)
v_mfma_f32_32x32x16_bf16 v[112:127], v[48:51], v[144:147], v[112:127]
ds_read_b64_tr_b16 v[40:41], v4 offset:10240
s_waitcnt lgkmcnt(9)
v_mfma_f32_16x16x32_bf16 v[20:23], v[28:31], v[220:223], v[20:23]
ds_read_b64_tr_b16 v[42:43], v4 offset:10496
ds_read_b128 v[28:31], v9 offset:32
v_mov_b32 v16, -1
v_mov_b32 v17, -1
v_mov_b32 v18, -1
v_mov_b32 v19, -1
v_cvt_pk_bf16_f32 v104, v104, v105
v_mfma_f32_32x32x16_bf16 v[112:127], v[52:55], v[148:151], v[112:127]
ds_read_b64_tr_b16 v[44:45], v4 offset:11264
v_cvt_pk_bf16_f32 v105, v106, v107
ds_read_b64_tr_b16 v[46:47], v4 offset:11520
v_cvt_pk_bf16_f32 v106, v108, v109
s_waitcnt lgkmcnt(11)
v_mfma_f32_32x32x16_bf16 v[112:127], v[56:59], v[152:155], v[112:127]
ds_read_b64_tr_b16 v[48:49], v4 offset:12288
s_waitcnt lgkmcnt(9)
v_mfma_f32_16x16x32_bf16 v[20:23], v[24:27], v[224:227], v[20:23]
ds_read_b64_tr_b16 v[50:51], v4 offset:12544
ds_read_b128 v[24:27], v9 offset:64
s_add_u32 s40, s67, 0x4000
buffer_store_dwordx4 v[16:19], v1, s[44:47], s40 offen sc1
v_cvt_pk_bf16_f32 v107, v110, v111
ds_write_b128 v2, v[104:107] offset:1024
v_mfma_f32_32x32x16_bf16 v[112:127], v[60:63], v[156:159], v[112:127]
ds_read_b64_tr_b16 v[52:53], v4 offset:13312
ds_read_b64_tr_b16 v[54:55], v4 offset:13568
s_waitcnt lgkmcnt(12)
v_mfma_f32_32x32x16_bf16 v[112:127], v[32:35], v[160:163], v[112:127]
ds_read_b64_tr_b16 v[56:57], v4 offset:14336
s_waitcnt lgkmcnt(9)
v_mfma_f32_16x16x32_bf16 v[20:23], v[28:31], v[228:231], v[20:23]
ds_read_b64_tr_b16 v[58:59], v4 offset:14592
ds_read_b128 v[28:31], v9 offset:96
v_mfma_f32_32x32x16_bf16 v[112:127], v[36:39], v[164:167], v[112:127]
ds_read_b64_tr_b16 v[60:61], v4 offset:15360
ds_read_b64_tr_b16 v[62:63], v4 offset:15616
s_waitcnt lgkmcnt(7)
s_barrier
v_mfma_f32_32x32x16_bf16 v[112:127], v[40:43], v[168:171], v[112:127]
ds_read_b64_tr_b16 v[32:33], v3
v_mfma_f32_16x16x32_bf16 v[20:23], v[24:27], v[232:235], v[20:23]
ds_read_b64_tr_b16 v[34:35], v3 offset:256
ds_read_b128 v[24:27], v9 offset:128
v_mfma_f32_32x32x16_bf16 v[112:127], v[44:47], v[172:175], v[112:127]
ds_read_b64_tr_b16 v[36:37], v3 offset:1024
ds_read_b64_tr_b16 v[38:39], v3 offset:1280
s_waitcnt lgkmcnt(10)
v_mfma_f32_32x32x16_bf16 v[112:127], v[48:51], v[176:179], v[112:127]
ds_read_b64_tr_b16 v[40:41], v3 offset:2048
s_waitcnt lgkmcnt(8)
v_mfma_f32_16x16x32_bf16 v[20:23], v[28:31], v[236:239], v[20:23]
ds_read_b64_tr_b16 v[42:43], v3 offset:2304
ds_read_b128 v[28:31], v9 offset:160
v_mfma_f32_32x32x16_bf16 v[112:127], v[52:55], v[180:183], v[112:127]
ds_read_b64_tr_b16 v[44:45], v3 offset:3072
ds_read_b64_tr_b16 v[46:47], v3 offset:3328
s_waitcnt lgkmcnt(10)
v_mfma_f32_32x32x16_bf16 v[112:127], v[56:59], v[184:187], v[112:127]
ds_read_b64_tr_b16 v[48:49], v3 offset:4096
s_waitcnt lgkmcnt(8)
v_mfma_f32_16x16x32_bf16 v[20:23], v[24:27], v[240:243], v[20:23]
ds_read_b64_tr_b16 v[50:51], v3 offset:4352
ds_read_b128 v[24:27], v9 offset:192
v_mfma_f32_32x32x16_bf16 v[112:127], v[60:63], v[188:191], v[112:127]
ds_read_b64_tr_b16 v[52:53], v3 offset:5120
ds_read_b64_tr_b16 v[54:55], v3 offset:5376
s_waitcnt lgkmcnt(10)
v_mfma_f32_32x32x16_bf16 v[112:127], v[32:35], v[192:195], v[112:127]
ds_read_b64_tr_b16 v[56:57], v3 offset:6144
s_waitcnt lgkmcnt(8)
v_mfma_f32_16x16x32_bf16 v[20:23], v[28:31], v[244:247], v[20:23]
ds_read_b64_tr_b16 v[58:59], v3 offset:6400
ds_read_b128 v[28:31], v9 offset:224
buffer_store_dwordx4 v[16:19], v1, s[44:47], s40 offen offset:512 sc1
v_mfma_f32_32x32x16_bf16 v[112:127], v[36:39], v[196:199], v[112:127]
ds_read_b64_tr_b16 v[60:61], v3 offset:7168
ds_read_b64_tr_b16 v[62:63], v3 offset:7424
s_waitcnt lgkmcnt(10)
v_mfma_f32_32x32x16_bf16 v[112:127], v[40:43], v[200:203], v[112:127]
ds_read_b64_tr_b16 v[32:33], v3 offset:8192
s_waitcnt lgkmcnt(8)
v_mfma_f32_16x16x32_bf16 v[20:23], v[24:27], v[248:251], v[20:23]
ds_read_b64_tr_b16 v[34:35], v3 offset:8448
v_mfma_f32_32x32x16_bf16 v[112:127], v[44:47], v[204:207], v[112:127]
ds_read_b64_tr_b16 v[36:37], v3 offset:9216
ds_read_b64_tr_b16 v[38:39], v3 offset:9472
s_waitcnt lgkmcnt(9)
v_mfma_f32_32x32x16_bf16 v[112:127], v[48:51], v[208:211], v[112:127]
ds_read_b64_tr_b16 v[40:41], v3 offset:10240
s_waitcnt lgkmcnt(7)
v_mfma_f32_16x16x32_bf16 v[20:23], v[28:31], v[252:255], v[20:23]
ds_read_b64_tr_b16 v[42:43], v3 offset:10496
v_mfma_f32_32x32x16_bf16 v[112:127], v[52:55], v[212:215], v[112:127]
ds_read_b64_tr_b16 v[44:45], v3 offset:11264
ds_read_b64_tr_b16 v[46:47], v3 offset:11520
s_waitcnt lgkmcnt(8)
v_mfma_f32_32x32x16_bf16 v[112:127], v[56:59], v[216:219], v[112:127]
ds_read_b64_tr_b16 v[48:49], v3 offset:12288
s_nop 0
v_mul_f32 v12, s56, v20
ds_read_b64_tr_b16 v[50:51], v3 offset:12544
v_mfma_f32_32x32x16_bf16 v[112:127], v[60:63], v[220:223], v[112:127]
ds_read_b64_tr_b16 v[52:53], v3 offset:13312
v_mul_f32 v13, s57, v20
ds_read_b64_tr_b16 v[54:55], v3 offset:13568
s_waitcnt lgkmcnt(8)
v_mfma_f32_32x32x16_bf16 v[112:127], v[32:35], v[224:227], v[112:127]
ds_read_b64_tr_b16 v[56:57], v3 offset:14336
v_exp_f32 v12, v12
ds_read_b64_tr_b16 v[58:59], v3 offset:14592
v_mfma_f32_32x32x16_bf16 v[112:127], v[36:39], v[228:231], v[112:127]
ds_read_b64_tr_b16 v[60:61], v3 offset:15360
v_exp_f32 v13, v13
ds_read_b64_tr_b16 v[62:63], v3 offset:15616
v_add_f32 v12, 1.0, v12
s_barrier
s_waitcnt lgkmcnt(8)
v_mfma_f32_32x32x16_bf16 v[112:127], v[40:43], v[232:235], v[112:127]
ds_read_b64_tr_b16 v[32:33], v3 offset:16384
s_add_u32 s40, s67, 0xc000
ds_read_b64_tr_b16 v[34:35], v3 offset:16640
buffer_store_dwordx4 v[16:19], v1, s[44:47], s40 offen sc1
v_add_f32 v13, 1.0, v13
v_min_f32 v8, 0x7e967699, v12
v_mfma_f32_32x32x16_bf16 v[112:127], v[44:47], v[236:239], v[112:127]
ds_read_b64_tr_b16 v[36:37], v3 offset:17408
v_rcp_f32 v13, v13
ds_read_b64_tr_b16 v[38:39], v3 offset:17664
s_waitcnt lgkmcnt(8)
v_mfma_f32_32x32x16_bf16 v[112:127], v[48:51], v[240:243], v[112:127]
ds_read_b64_tr_b16 v[40:41], v3 offset:18432
v_and_b32 v11, 31, v0
ds_read_b64_tr_b16 v[42:43], v3 offset:18688
v_lshlrev_b32 v11, 2, v11
v_mfma_f32_32x32x16_bf16 v[112:127], v[52:55], v[244:247], v[112:127]
ds_read_b64_tr_b16 v[44:45], v3 offset:19456
v_add_u32 v11, s70, v11
ds_read_b64_tr_b16 v[46:47], v3 offset:19712
ds_write_b32 v11, v13
s_waitcnt lgkmcnt(9)
v_mfma_f32_32x32x16_bf16 v[112:127], v[56:59], v[248:251], v[112:127]
ds_read_b64_tr_b16 v[48:49], v3 offset:20480
buffer_load_dword v11, v7, s[52:55], 0 offen sc1
ds_read_b64_tr_b16 v[50:51], v3 offset:20736
v_mfma_f32_32x32x16_bf16 v[112:127], v[60:63], v[252:255], v[112:127]
ds_read_b64_tr_b16 v[52:53], v3 offset:21504
ds_read_b64_tr_b16 v[54:55], v3 offset:21760
s_waitcnt lgkmcnt(9)
v_mfma_f32_32x32x16_bf16 v[64:79], v[32:35], v[128:131], 0
ds_read_b64_tr_b16 v[56:57], v3 offset:22528
ds_read_b64_tr_b16 v[58:59], v3 offset:22784
v_mfma_f32_32x32x16_bf16 v[64:79], v[36:39], v[132:135], v[64:79]
ds_read_b64_tr_b16 v[60:61], v3 offset:23552
ds_read_b64_tr_b16 v[62:63], v3 offset:23808
s_waitcnt lgkmcnt(9)
v_mfma_f32_32x32x16_bf16 v[64:79], v[40:43], v[136:139], v[64:79]
ds_read_b64_tr_b16 v[32:33], v3 offset:24576
ds_read_b64_tr_b16 v[34:35], v3 offset:24832
v_mfma_f32_32x32x16_bf16 v[64:79], v[44:47], v[140:143], v[64:79]
ds_read_b64_tr_b16 v[36:37], v3 offset:25600
ds_read_b64_tr_b16 v[38:39], v3 offset:25856
s_waitcnt lgkmcnt(8)
v_mfma_f32_32x32x16_bf16 v[64:79], v[48:51], v[144:147], v[64:79]
ds_read_b64_tr_b16 v[40:41], v3 offset:26624
buffer_store_dwordx4 v[16:19], v1, s[44:47], s40 offen offset:512 sc1
ds_read_b64_tr_b16 v[42:43], v3 offset:26880
v_mfma_f32_32x32x16_bf16 v[64:79], v[52:55], v[148:151], v[64:79]
ds_read_b64_tr_b16 v[44:45], v3 offset:27648
ds_read_b64_tr_b16 v[46:47], v3 offset:27904
s_waitcnt lgkmcnt(8)
v_mfma_f32_32x32x16_bf16 v[64:79], v[56:59], v[152:155], v[64:79]
ds_read_b64_tr_b16 v[48:49], v3 offset:28672
ds_read_b64_tr_b16 v[50:51], v3 offset:28928
v_mfma_f32_32x32x16_bf16 v[64:79], v[60:63], v[156:159], v[64:79]
ds_read_b64_tr_b16 v[52:53], v3 offset:29696
ds_read_b64_tr_b16 v[54:55], v3 offset:29952
s_waitcnt lgkmcnt(8)
v_mfma_f32_32x32x16_bf16 v[64:79], v[32:35], v[160:163], v[64:79]
ds_read_b64_tr_b16 v[56:57], v3 offset:30720
ds_read_b64_tr_b16 v[58:59], v3 offset:30976
v_mfma_f32_32x32x16_bf16 v[64:79], v[36:39], v[164:167], v[64:79]
ds_read_b64_tr_b16 v[60:61], v3 offset:31744
ds_read_b64_tr_b16 v[62:63], v3 offset:32000
s_barrier
s_waitcnt lgkmcnt(8)
v_mfma_f32_32x32x16_bf16 v[64:79], v[40:43], v[168:171], v[64:79]
ds_read_b64_tr_b16 v[32:33], v3 offset:32768
ds_read_b64_tr_b16 v[34:35], v3 offset:33024
v_mfma_f32_32x32x16_bf16 v[64:79], v[44:47], v[172:175], v[64:79]
ds_read_b64_tr_b16 v[36:37], v3 offset:33792
ds_read_b64_tr_b16 v[38:39], v3 offset:34048
s_waitcnt lgkmcnt(8)
v_mfma_f32_32x32x16_bf16 v[64:79], v[48:51], v[176:179], v[64:79]
ds_read_b64_tr_b16 v[40:41], v3 offset:34816
ds_read_b64_tr_b16 v[42:43], v3 offset:35072
v_mfma_f32_32x32x16_bf16 v[64:79], v[52:55], v[180:183], v[64:79]
ds_read_b64_tr_b16 v[44:45], v3 offset:35840
ds_read_b64_tr_b16 v[46:47], v3 offset:36096
s_waitcnt lgkmcnt(8)
v_mfma_f32_32x32x16_bf16 v[64:79], v[56:59], v[184:187], v[64:79]
ds_read_b64_tr_b16 v[48:49], v3 offset:36864
buffer_store_dwordx4 v[16:19], v1, s[44:47], s68 offen sc1
ds_read_b64_tr_b16 v[50:51], v3 offset:37120
v_mfma_f32_32x32x16_bf16 v[64:79], v[60:63], v[188:191], v[64:79]
ds_read_b64_tr_b16 v[52:53], v3 offset:37888
ds_read_b64_tr_b16 v[54:55], v3 offset:38144
s_waitcnt lgkmcnt(8)
v_mfma_f32_32x32x16_bf16 v[64:79], v[32:35], v[192:195], v[64:79]
ds_read_b64_tr_b16 v[56:57], v3 offset:38912
ds_read_b64_tr_b16 v[58:59], v3 offset:39168
v_mfma_f32_32x32x16_bf16 v[64:79], v[36:39], v[196:199], v[64:79]
ds_read_b64_tr_b16 v[60:61], v3 offset:39936
ds_read_b64_tr_b16 v[62:63], v3 offset:40192
s_waitcnt lgkmcnt(8)
v_mfma_f32_32x32x16_bf16 v[64:79], v[40:43], v[200:203], v[64:79]
ds_read_b64_tr_b16 v[32:33], v3 offset:40960
ds_read_b64_tr_b16 v[34:35], v3 offset:41216
v_mfma_f32_32x32x16_bf16 v[64:79], v[44:47], v[204:207], v[64:79]
ds_read_b64_tr_b16 v[36:37], v3 offset:41984
ds_read_b64_tr_b16 v[38:39], v3 offset:42240
s_waitcnt lgkmcnt(8)
v_mfma_f32_32x32x16_bf16 v[64:79], v[48:51], v[208:211], v[64:79]
ds_read_b64_tr_b16 v[40:41], v3 offset:43008
ds_read_b64_tr_b16 v[42:43], v3 offset:43264
v_mfma_f32_32x32x16_bf16 v[64:79], v[52:55], v[212:215], v[64:79]
ds_read_b64_tr_b16 v[44:45], v3 offset:44032
ds_read_b64_tr_b16 v[46:47], v3 offset:44288
s_waitcnt lgkmcnt(8)
v_mfma_f32_32x32x16_bf16 v[64:79], v[56:59], v[216:219], v[64:79]
ds_read_b64_tr_b16 v[48:49], v3 offset:45056
ds_read_b64_tr_b16 v[50:51], v3 offset:45312
v_mfma_f32_32x32x16_bf16 v[64:79], v[60:63], v[220:223], v[64:79]
ds_read_b64_tr_b16 v[52:53], v3 offset:46080
ds_read_b64_tr_b16 v[54:55], v3 offset:46336
s_waitcnt lgkmcnt(8)
v_mfma_f32_32x32x16_bf16 v[64:79], v[32:35], v[224:227], v[64:79]
ds_read_b64_tr_b16 v[56:57], v3 offset:47104
ds_read_b64_tr_b16 v[58:59], v3 offset:47360
v_mfma_f32_32x32x16_bf16 v[64:79], v[36:39], v[228:231], v[64:79]
ds_read_b64_tr_b16 v[60:61], v3 offset:48128
ds_read_b64_tr_b16 v[62:63], v3 offset:48384
s_barrier
s_waitcnt lgkmcnt(8)
v_mfma_f32_32x32x16_bf16 v[64:79], v[40:43], v[232:235], v[64:79]
ds_read_b128 v[32:35], v5 offset:49152
v_mfma_f32_32x32x16_bf16 v[64:79], v[44:47], v[236:239], v[64:79]
ds_read_b128 v[36:39], v5 offset:50176
s_waitcnt lgkmcnt(6)
v_mfma_f32_32x32x16_bf16 v[64:79], v[48:51], v[240:243], v[64:79]
ds_read_b128 v[40:43], v5 offset:51200
v_mfma_f32_32x32x16_bf16 v[64:79], v[52:55], v[244:247], v[64:79]
ds_read_b128 v[44:47], v5 offset:52224
s_waitcnt lgkmcnt(4)
v_mfma_f32_32x32x16_bf16 v[64:79], v[56:59], v[248:251], v[64:79]
ds_read_b128 v[48:51], v5 offset:53248
v_mfma_f32_32x32x16_bf16 v[64:79], v[60:63], v[252:255], v[64:79]
ds_read_b128 v[52:55], v5 offset:54272
s_waitcnt lgkmcnt(4)
v_mfma_f32_32x32x16_bf16 v[80:95], v[32:35], v[128:131], 0
ds_read_b128 v[56:59], v5 offset:55296
v_mfma_f32_32x32x16_bf16 v[80:95], v[36:39], v[132:135], v[80:95]
ds_read_b128 v[60:63], v5 offset:56320
v_mul_f32 v12, s57, v112
v_mul_f32 v13, s57, v113
s_waitcnt lgkmcnt(4)
v_mfma_f32_32x32x16_bf16 v[80:95], v[40:43], v[136:139], v[80:95]
ds_read_b128 v[32:35], v5 offset:57344
v_mul_f32 v14, s57, v114
v_mul_f32 v15, s57, v115
v_mfma_f32_32x32x16_bf16 v[80:95], v[44:47], v[140:143], v[80:95]
ds_read_b128 v[36:39], v5 offset:58368
v_exp_f32 v12, v12
v_mul_f32 v112, v112, v64
s_waitcnt lgkmcnt(4)
v_mfma_f32_32x32x16_bf16 v[80:95], v[48:51], v[144:147], v[80:95]
ds_read_b128 v[40:43], v5 offset:59392
v_exp_f32 v13, v13
v_mfma_f32_32x32x16_bf16 v[80:95], v[52:55], v[148:151], v[80:95]
ds_read_b128 v[44:47], v5 offset:60416
v_mul_f32 v113, v113, v65
v_exp_f32 v14, v14
s_waitcnt lgkmcnt(4)
v_mfma_f32_32x32x16_bf16 v[80:95], v[56:59], v[152:155], v[80:95]
ds_read_b128 v[48:51], v5 offset:61440
v_mul_f32 v114, v114, v66
v_mfma_f32_32x32x16_bf16 v[80:95], v[60:63], v[156:159], v[80:95]
ds_read_b128 v[52:55], v5 offset:62464
v_exp_f32 v15, v15
v_mul_f32 v115, v115, v67
v_fma_f32 v12, v12, v8, v8
s_waitcnt lgkmcnt(4)
v_mfma_f32_32x32x16_bf16 v[80:95], v[32:35], v[160:163], v[80:95]
ds_read_b128 v[56:59], v5 offset:63488
v_fma_f32 v13, v13, v8, v8
v_fma_f32 v14, v14, v8, v8
v_mfma_f32_32x32x16_bf16 v[80:95], v[36:39], v[164:167], v[80:95]
ds_read_b128 v[60:63], v5 offset:64512
v_fma_f32 v15, v15, v8, v8
v_rcp_f32 v12, v12
s_barrier
s_waitcnt lgkmcnt(4)
v_mfma_f32_32x32x16_bf16 v[80:95], v[40:43], v[168:171], v[80:95]
ds_read_b128 v[32:35], v6
v_rcp_f32 v13, v13
v_mfma_f32_32x32x16_bf16 v[80:95], v[44:47], v[172:175], v[80:95]
ds_read_b128 v[36:39], v6 offset:1024
v_rcp_f32 v14, v14
s_waitcnt lgkmcnt(4)
v_mfma_f32_32x32x16_bf16 v[80:95], v[48:51], v[176:179], v[80:95]
ds_read_b128 v[40:43], v6 offset:2048
v_rcp_f32 v15, v15
v_mul_f32 v112, v112, v12
v_mfma_f32_32x32x16_bf16 v[80:95], v[52:55], v[180:183], v[80:95]
ds_read_b128 v[44:47], v6 offset:3072
v_mul_f32 v113, v113, v13
v_mul_f32 v114, v114, v14
v_mul_f32 v115, v115, v15
s_waitcnt lgkmcnt(4)
v_mfma_f32_32x32x16_bf16 v[80:95], v[56:59], v[184:187], v[80:95]
ds_read_b128 v[48:51], v6 offset:4096
v_cvt_pk_bf16_f32 v64, v112, v113
v_cvt_pk_bf16_f32 v65, v114, v115
v_mfma_f32_32x32x16_bf16 v[80:95], v[60:63], v[188:191], v[80:95]
ds_read_b128 v[52:55], v6 offset:5120
v_mul_f32 v16, s57, v116
v_mul_f32 v17, s57, v117
v_mul_f32 v18, s57, v118
s_waitcnt lgkmcnt(4)
v_mfma_f32_32x32x16_bf16 v[80:95], v[32:35], v[192:195], v[80:95]
ds_read_b128 v[56:59], v6 offset:6144
v_mul_f32 v19, s57, v119
v_mfma_f32_32x32x16_bf16 v[80:95], v[36:39], v[196:199], v[80:95]
ds_read_b128 v[60:63], v6 offset:7168
v_exp_f32 v16, v16
v_mul_f32 v116, v116, v68
s_waitcnt lgkmcnt(4)
v_mfma_f32_32x32x16_bf16 v[80:95], v[40:43], v[200:203], v[80:95]
ds_read_b128 v[32:35], v6 offset:8192
v_exp_f32 v17, v17
v_mul_f32 v117, v117, v69
v_mfma_f32_32x32x16_bf16 v[80:95], v[44:47], v[204:207], v[80:95]
ds_read_b128 v[36:39], v6 offset:9216
v_exp_f32 v18, v18
v_mul_f32 v118, v118, v70
s_waitcnt lgkmcnt(4)
v_mfma_f32_32x32x16_bf16 v[80:95], v[48:51], v[208:211], v[80:95]
ds_read_b128 v[40:43], v6 offset:10240
v_exp_f32 v19, v19
v_mfma_f32_32x32x16_bf16 v[80:95], v[52:55], v[212:215], v[80:95]
ds_read_b128 v[44:47], v6 offset:11264
v_mul_f32 v119, v119, v71
v_fma_f32 v16, v16, v8, v8
v_fma_f32 v17, v17, v8, v8
s_waitcnt lgkmcnt(4)
v_mfma_f32_32x32x16_bf16 v[80:95], v[56:59], v[216:219], v[80:95]
ds_read_b128 v[48:51], v6 offset:12288
v_fma_f32 v18, v18, v8, v8
v_fma_f32 v19, v19, v8, v8
v_mfma_f32_32x32x16_bf16 v[80:95], v[60:63], v[220:223], v[80:95]
ds_read_b128 v[52:55], v6 offset:13312
v_rcp_f32 v16, v16
s_waitcnt lgkmcnt(4)
v_mfma_f32_32x32x16_bf16 v[80:95], v[32:35], v[224:227], v[80:95]
ds_read_b128 v[56:59], v6 offset:14336
v_rcp_f32 v17, v17
v_mfma_f32_32x32x16_bf16 v[80:95], v[36:39], v[228:231], v[80:95]
ds_read_b128 v[60:63], v6 offset:15360
v_rcp_f32 v18, v18
v_rcp_f32 v19, v19
s_barrier
s_waitcnt lgkmcnt(4)
v_mfma_f32_32x32x16_bf16 v[80:95], v[40:43], v[232:235], v[80:95]
ds_read_b128 v[32:35], v5
v_mul_f32 v116, v116, v16
v_mul_f32 v117, v117, v17
v_mfma_f32_32x32x16_bf16 v[80:95], v[44:47], v[236:239], v[80:95]
ds_read_b128 v[36:39], v5 offset:1024
v_mul_f32 v118, v118, v18
v_mul_f32 v119, v119, v19
v_cvt_pk_bf16_f32 v66, v116, v117
s_waitcnt lgkmcnt(4)
v_mfma_f32_32x32x16_bf16 v[80:95], v[48:51], v[240:243], v[80:95]
ds_read_b128 v[40:43], v5 offset:2048
v_cvt_pk_bf16_f32 v67, v118, v119
s_add_u32 s10, s67, 0
v_mfma_f32_32x32x16_bf16 v[80:95], v[52:55], v[244:247], v[80:95]
ds_read_b128 v[44:47], v5 offset:3072
buffer_store_dwordx4 v[64:67], v1, s[44:47], s10 offen sc1
v_mul_f32 v12, s57, v120
s_waitcnt lgkmcnt(4)
v_mfma_f32_32x32x16_bf16 v[80:95], v[56:59], v[248:251], v[80:95]
ds_read_b128 v[48:51], v5 offset:4096
v_mul_f32 v13, s57, v121
v_mul_f32 v14, s57, v122
v_mul_f32 v15, s57, v123
v_mfma_f32_32x32x16_bf16 v[80:95], v[60:63], v[252:255], v[80:95]
ds_read_b128 v[52:55], v5 offset:5120
v_exp_f32 v12, v12
s_waitcnt lgkmcnt(4)
v_mfma_f32_32x32x16_bf16 v[96:111], v[32:35], v[128:131], 0
ds_read_b128 v[56:59], v5 offset:6144
v_mul_f32 v120, v120, v72
v_exp_f32 v13, v13
v_mfma_f32_32x32x16_bf16 v[96:111], v[36:39], v[132:135], v[96:111]
ds_read_b128 v[60:63], v5 offset:7168
v_mul_f32 v121, v121, v73
s_waitcnt lgkmcnt(4)
v_mfma_f32_32x32x16_bf16 v[96:111], v[40:43], v[136:139], v[96:111]
ds_read_b128 v[32:35], v5 offset:8192
v_exp_f32 v14, v14
v_mul_f32 v122, v122, v74
v_mfma_f32_32x32x16_bf16 v[96:111], v[44:47], v[140:143], v[96:111]
ds_read_b128 v[36:39], v5 offset:9216
v_exp_f32 v15, v15
v_mul_f32 v123, v123, v75
s_waitcnt lgkmcnt(4)
v_mfma_f32_32x32x16_bf16 v[96:111], v[48:51], v[144:147], v[96:111]
ds_read_b128 v[40:43], v5 offset:10240
v_fma_f32 v12, v12, v8, v8
v_fma_f32 v13, v13, v8, v8
v_fma_f32 v14, v14, v8, v8
v_mfma_f32_32x32x16_bf16 v[96:111], v[52:55], v[148:151], v[96:111]
ds_read_b128 v[44:47], v5 offset:11264
v_fma_f32 v15, v15, v8, v8
s_waitcnt lgkmcnt(4)
v_mfma_f32_32x32x16_bf16 v[96:111], v[56:59], v[152:155], v[96:111]
ds_read_b128 v[48:51], v5 offset:12288
v_rcp_f32 v12, v12
v_rcp_f32 v13, v13
v_mfma_f32_32x32x16_bf16 v[96:111], v[60:63], v[156:159], v[96:111]
ds_read_b128 v[52:55], v5 offset:13312
v_rcp_f32 v14, v14
s_waitcnt lgkmcnt(4)
v_mfma_f32_32x32x16_bf16 v[96:111], v[32:35], v[160:163], v[96:111]
ds_read_b128 v[56:59], v5 offset:14336
v_rcp_f32 v15, v15
v_mul_f32 v120, v120, v12
v_mfma_f32_32x32x16_bf16 v[96:111], v[36:39], v[164:167], v[96:111]
ds_read_b128 v[60:63], v5 offset:15360
v_mul_f32 v121, v121, v13
v_mul_f32 v122, v122, v14
s_barrier
s_waitcnt lgkmcnt(4)
v_mfma_f32_32x32x16_bf16 v[96:111], v[40:43], v[168:171], v[96:111]
ds_read_b128 v[32:35], v5 offset:16384
v_mul_f32 v123, v123, v15
v_cvt_pk_bf16_f32 v72, v120, v121
v_cvt_pk_bf16_f32 v73, v122, v123
v_mfma_f32_32x32x16_bf16 v[96:111], v[44:47], v[172:175], v[96:111]
ds_read_b128 v[36:39], v5 offset:17408
v_mul_f32 v16, s57, v124
v_mul_f32 v17, s57, v125
s_waitcnt lgkmcnt(4)
v_mfma_f32_32x32x16_bf16 v[96:111], v[48:51], v[176:179], v[96:111]
ds_read_b128 v[40:43], v5 offset:18432
v_mul_f32 v18, s57, v126
v_mul_f32 v19, s57, v127
v_mfma_f32_32x32x16_bf16 v[96:111], v[52:55], v[180:183], v[96:111]
ds_read_b128 v[44:47], v5 offset:19456
v_exp_f32 v16, v16
v_mul_f32 v124, v124, v76
s_waitcnt lgkmcnt(4)
v_mfma_f32_32x32x16_bf16 v[96:111], v[56:59], v[184:187], v[96:111]
ds_read_b128 v[48:51], v5 offset:20480
v_exp_f32 v17, v17
v_mul_f32 v125, v125, v77
v_mfma_f32_32x32x16_bf16 v[96:111], v[60:63], v[188:191], v[96:111]
ds_read_b128 v[52:55], v5 offset:21504
v_exp_f32 v18, v18
s_waitcnt lgkmcnt(4)
v_mfma_f32_32x32x16_bf16 v[96:111], v[32:35], v[192:195], v[96:111]
ds_read_b128 v[56:59], v5 offset:22528
v_mul_f32 v126, v126, v78
v_exp_f32 v19, v19
v_mfma_f32_32x32x16_bf16 v[96:111], v[36:39], v[196:199], v[96:111]
ds_read_b128 v[60:63], v5 offset:23552
v_mul_f32 v127, v127, v79
v_fma_f32 v16, v16, v8, v8
s_waitcnt lgkmcnt(4)
v_mfma_f32_32x32x16_bf16 v[96:111], v[40:43], v[200:203], v[96:111]
ds_read_b128 v[32:35], v5 offset:24576
v_fma_f32 v17, v17, v8, v8
v_fma_f32 v18, v18, v8, v8
v_fma_f32 v19, v19, v8, v8
v_mfma_f32_32x32x16_bf16 v[96:111], v[44:47], v[204:207], v[96:111]
ds_read_b128 v[36:39], v5 offset:25600
v_rcp_f32 v16, v16
s_waitcnt lgkmcnt(4)
v_mfma_f32_32x32x16_bf16 v[96:111], v[48:51], v[208:211], v[96:111]
ds_read_b128 v[40:43], v5 offset:26624
v_rcp_f32 v17, v17
v_mfma_f32_32x32x16_bf16 v[96:111], v[52:55], v[212:215], v[96:111]
ds_read_b128 v[44:47], v5 offset:27648
v_rcp_f32 v18, v18
s_waitcnt lgkmcnt(4)
v_mfma_f32_32x32x16_bf16 v[96:111], v[56:59], v[216:219], v[96:111]
ds_read_b128 v[48:51], v5 offset:28672
v_rcp_f32 v19, v19
v_mul_f32 v124, v124, v16
v_mul_f32 v125, v125, v17
v_mfma_f32_32x32x16_bf16 v[96:111], v[60:63], v[220:223], v[96:111]
ds_read_b128 v[52:55], v5 offset:29696
v_mul_f32 v126, v126, v18
v_mul_f32 v127, v127, v19
s_waitcnt lgkmcnt(4)
v_mfma_f32_32x32x16_bf16 v[96:111], v[32:35], v[224:227], v[96:111]
ds_read_b128 v[56:59], v5 offset:30720
v_cvt_pk_bf16_f32 v74, v124, v125
v_cvt_pk_bf16_f32 v75, v126, v127
buffer_store_dwordx4 v[72:75], v1, s[44:47], s10 offen offset:512 sc1
v_mfma_f32_32x32x16_bf16 v[96:111], v[36:39], v[228:231], v[96:111]
ds_read_b128 v[60:63], v5 offset:31744
s_barrier
s_waitcnt lgkmcnt(4)
v_mfma_f32_32x32x16_bf16 v[96:111], v[40:43], v[232:235], v[96:111]
ds_read_b128 v[32:35], v5 offset:32768
v_mfma_f32_32x32x16_bf16 v[96:111], v[44:47], v[236:239], v[96:111]
ds_read_b128 v[36:39], v5 offset:33792
s_waitcnt lgkmcnt(4)
v_mfma_f32_32x32x16_bf16 v[96:111], v[48:51], v[240:243], v[96:111]
ds_read_b128 v[40:43], v5 offset:34816
v_mfma_f32_32x32x16_bf16 v[96:111], v[52:55], v[244:247], v[96:111]
ds_read_b128 v[44:47], v5 offset:35840
s_waitcnt lgkmcnt(4)
v_mfma_f32_32x32x16_bf16 v[96:111], v[56:59], v[248:251], v[96:111]
ds_read_b128 v[48:51], v5 offset:36864
v_mfma_f32_32x32x16_bf16 v[96:111], v[60:63], v[252:255], v[96:111]
ds_read_b128 v[52:55], v5 offset:37888
s_waitcnt lgkmcnt(4)
v_mfma_f32_32x32x16_bf16 v[112:127], v[32:35], v[128:131], 0
ds_read_b128 v[56:59], v5 offset:38912
v_mfma_f32_32x32x16_bf16 v[112:127], v[36:39], v[132:135], v[112:127]
ds_read_b128 v[60:63], v5 offset:39936
v_mul_f32 v12, s57, v80
v_mul_f32 v13, s57, v81
v_mul_f32 v14, s57, v82
s_waitcnt lgkmcnt(4)
v_mfma_f32_32x32x16_bf16 v[112:127], v[40:43], v[136:139], v[112:127]
ds_read_b128 v[32:35], v5 offset:40960
v_mul_f32 v15, s57, v83
v_exp_f32 v12, v12
v_mul_f32 v80, v80, v96
v_mfma_f32_32x32x16_bf16 v[112:127], v[44:47], v[140:143], v[112:127]
ds_read_b128 v[36:39], v5 offset:41984
v_exp_f32 v13, v13
v_mul_f32 v81, v81, v97
s_waitcnt lgkmcnt(4)
v_mfma_f32_32x32x16_bf16 v[112:127], v[48:51], v[144:147], v[112:127]
ds_read_b128 v[40:43], v5 offset:43008
v_exp_f32 v14, v14
v_mul_f32 v82, v82, v98
v_exp_f32 v15, v15
v_mfma_f32_32x32x16_bf16 v[112:127], v[52:55], v[148:151], v[112:127]
ds_read_b128 v[44:47], v5 offset:44032
v_mul_f32 v83, v83, v99
v_fma_f32 v12, v12, v8, v8
v_fma_f32 v13, v13, v8, v8
v_fma_f32 v14, v14, v8, v8
s_waitcnt lgkmcnt(4)
v_mfma_f32_32x32x16_bf16 v[112:127], v[56:59], v[152:155], v[112:127]
ds_read_b128 v[48:51], v5 offset:45056
v_fma_f32 v15, v15, v8, v8
v_rcp_f32 v12, v12
v_mfma_f32_32x32x16_bf16 v[112:127], v[60:63], v[156:159], v[112:127]
ds_read_b128 v[52:55], v5 offset:46080
v_rcp_f32 v13, v13
v_rcp_f32 v14, v14
s_waitcnt lgkmcnt(4)
v_mfma_f32_32x32x16_bf16 v[112:127], v[32:35], v[160:163], v[112:127]
ds_read_b128 v[56:59], v5 offset:47104
v_rcp_f32 v15, v15
v_mul_f32 v80, v80, v12
v_mul_f32 v81, v81, v13
v_mfma_f32_32x32x16_bf16 v[112:127], v[36:39], v[164:167], v[112:127]
ds_read_b128 v[60:63], v5 offset:48128
v_mul_f32 v82, v82, v14
v_mul_f32 v83, v83, v15
v_cvt_pk_bf16_f32 v96, v80, v81
v_cvt_pk_bf16_f32 v97, v82, v83
s_barrier
s_waitcnt lgkmcnt(4)
v_mfma_f32_32x32x16_bf16 v[112:127], v[40:43], v[168:171], v[112:127]
ds_read_b128 v[32:35], v5 offset:49152
v_mul_f32 v16, s57, v84
v_mul_f32 v17, s57, v85
v_mul_f32 v18, s57, v86
v_mul_f32 v19, s57, v87
v_mfma_f32_32x32x16_bf16 v[112:127], v[44:47], v[172:175], v[112:127]
ds_read_b128 v[36:39], v5 offset:50176
v_exp_f32 v16, v16
v_mul_f32 v84, v84, v100
s_waitcnt lgkmcnt(4)
v_mfma_f32_32x32x16_bf16 v[112:127], v[48:51], v[176:179], v[112:127]
ds_read_b128 v[40:43], v5 offset:51200
v_exp_f32 v17, v17
v_mul_f32 v85, v85, v101
v_exp_f32 v18, v18
v_mfma_f32_32x32x16_bf16 v[112:127], v[52:55], v[180:183], v[112:127]
ds_read_b128 v[44:47], v5 offset:52224
v_mul_f32 v86, v86, v102
v_exp_f32 v19, v19
v_mul_f32 v87, v87, v103
s_waitcnt lgkmcnt(4)
v_mfma_f32_32x32x16_bf16 v[112:127], v[56:59], v[184:187], v[112:127]
ds_read_b128 v[48:51], v5 offset:53248
v_fma_f32 v16, v16, v8, v8
v_fma_f32 v17, v17, v8, v8
v_fma_f32 v18, v18, v8, v8
v_fma_f32 v19, v19, v8, v8
v_mfma_f32_32x32x16_bf16 v[112:127], v[60:63], v[188:191], v[112:127]
ds_read_b128 v[52:55], v5 offset:54272
s_waitcnt vmcnt(4)
v_readfirstlane_b32 s58, v11
s_nop 1
s_cmp_lg_u32 s58, 0
s_cbranch_scc1 L_Ainit_ok
s_mov_b32 s59, 0x40000
L_Ainit_spin:
buffer_load_dword v11, v7, s[52:55], 0 offen sc1
s_waitcnt vmcnt(0)
v_readfirstlane_b32 s58, v11
s_sub_u32 s59, s59, 1
s_cmp_eq_u32 s59, 0
s_cbranch_scc1 L_Ainit_ok
s_cmp_lg_u32 s58, 0
s_cbranch_scc0 L_Ainit_spin
L_Ainit_ok:
v_rcp_f32 v16, v16
s_waitcnt lgkmcnt(4)
v_mfma_f32_32x32x16_bf16 v[112:127], v[32:35], v[192:195], v[112:127]
ds_read_b128 v[56:59], v5 offset:55296
s_waitcnt vmcnt(2)
s_waitcnt vmcnt(0)
v_mov_b32 v11, 1
buffer_atomic_add v11, v7, s[44:47], s69 offen sc1
v_rcp_f32 v17, v17
v_rcp_f32 v18, v18
v_mfma_f32_32x32x16_bf16 v[112:127], v[36:39], v[196:199], v[112:127]
ds_read_b128 v[60:63], v5 offset:56320
v_rcp_f32 v19, v19
v_mul_f32 v84, v84, v16
v_mul_f32 v85, v85, v17
v_mul_f32 v86, v86, v18
s_waitcnt lgkmcnt(4)
v_mfma_f32_32x32x16_bf16 v[112:127], v[40:43], v[200:203], v[112:127]
ds_read_b128 v[32:35], v5 offset:57344
v_mul_f32 v87, v87, v19
v_cvt_pk_bf16_f32 v98, v84, v85
v_cvt_pk_bf16_f32 v99, v86, v87
s_add_u32 s10, s67, 0x4000
v_mfma_f32_32x32x16_bf16 v[112:127], v[44:47], v[204:207], v[112:127]
ds_read_b128 v[36:39], v5 offset:58368
buffer_store_dwordx4 v[96:99], v1, s[44:47], s10 offen sc1
v_mul_f32 v12, s57, v88
v_mul_f32 v13, s57, v89
v_mul_f32 v14, s57, v90
s_waitcnt lgkmcnt(4)
v_mfma_f32_32x32x16_bf16 v[112:127], v[48:51], v[208:211], v[112:127]
ds_read_b128 v[40:43], v5 offset:59392
v_mul_f32 v15, s57, v91
v_exp_f32 v12, v12
v_mul_f32 v88, v88, v104
v_mfma_f32_32x32x16_bf16 v[112:127], v[52:55], v[212:215], v[112:127]
ds_read_b128 v[44:47], v5 offset:60416
v_exp_f32 v13, v13
v_mul_f32 v89, v89, v105
s_waitcnt lgkmcnt(4)
v_mfma_f32_32x32x16_bf16 v[112:127], v[56:59], v[216:219], v[112:127]
ds_read_b128 v[48:51], v5 offset:61440
v_exp_f32 v14, v14
v_mul_f32 v90, v90, v106
v_mfma_f32_32x32x16_bf16 v[112:127], v[60:63], v[220:223], v[112:127]
ds_read_b128 v[52:55], v5 offset:62464
v_exp_f32 v15, v15
v_mul_f32 v91, v91, v107
v_fma_f32 v12, v12, v8, v8
v_fma_f32 v13, v13, v8, v8
s_waitcnt lgkmcnt(4)
v_mfma_f32_32x32x16_bf16 v[112:127], v[32:35], v[224:227], v[112:127]
ds_read_b128 v[56:59], v5 offset:63488
v_fma_f32 v14, v14, v8, v8
v_fma_f32 v15, v15, v8, v8
v_rcp_f32 v12, v12
v_mfma_f32_32x32x16_bf16 v[112:127], v[36:39], v[228:231], v[112:127]
ds_read_b128 v[60:63], v5 offset:64512
v_rcp_f32 v13, v13
v_rcp_f32 v14, v14
s_barrier
s_waitcnt lgkmcnt(4)
v_mfma_f32_32x32x16_bf16 v[112:127], v[40:43], v[232:235], v[112:127]
ds_read_b128 v[32:35], v6
v_rcp_f32 v15, v15
v_mul_f32 v88, v88, v12
v_mul_f32 v89, v89, v13
v_mfma_f32_32x32x16_bf16 v[112:127], v[44:47], v[236:239], v[112:127]
ds_read_b128 v[36:39], v6 offset:1024
v_mul_f32 v90, v90, v14
v_mul_f32 v91, v91, v15
v_cvt_pk_bf16_f32 v104, v88, v89
v_cvt_pk_bf16_f32 v105, v90, v91
s_waitcnt lgkmcnt(4)
v_mfma_f32_32x32x16_bf16 v[112:127], v[48:51], v[240:243], v[112:127]
ds_read_b128 v[40:43], v6 offset:2048
v_mul_f32 v16, s57, v92
v_mul_f32 v17, s57, v93
v_mul_f32 v18, s57, v94
v_mul_f32 v19, s57, v95
v_mfma_f32_32x32x16_bf16 v[112:127], v[52:55], v[244:247], v[112:127]
ds_read_b128 v[44:47], v6 offset:3072
v_exp_f32 v16, v16
v_mul_f32 v92, v92, v108
s_waitcnt lgkmcnt(4)
v_mfma_f32_32x32x16_bf16 v[112:127], v[56:59], v[248:251], v[112:127]
ds_read_b128 v[48:51], v6 offset:4096
v_exp_f32 v17, v17
v_mul_f32 v93, v93, v109
v_mfma_f32_32x32x16_bf16 v[112:127], v[60:63], v[252:255], v[112:127]
ds_read_b128 v[52:55], v6 offset:5120
v_exp_f32 v18, v18
v_mul_f32 v94, v94, v110
v_exp_f32 v19, v19
s_waitcnt lgkmcnt(4)
v_mfma_f32_32x32x16_bf16 v[64:79], v[32:35], v[128:131], 0
ds_read_b128 v[56:59], v6 offset:6144
v_mul_f32 v95, v95, v111
v_fma_f32 v16, v16, v8, v8
v_fma_f32 v17, v17, v8, v8
v_fma_f32 v18, v18, v8, v8
v_mfma_f32_32x32x16_bf16 v[64:79], v[36:39], v[132:135], v[64:79]
ds_read_b128 v[60:63], v6 offset:7168
v_fma_f32 v19, v19, v8, v8
v_rcp_f32 v16, v16
s_waitcnt lgkmcnt(4)
v_mfma_f32_32x32x16_bf16 v[64:79], v[40:43], v[136:139], v[64:79]
ds_read_b128 v[32:35], v6 offset:8192
v_rcp_f32 v17, v17
v_rcp_f32 v18, v18
v_mfma_f32_32x32x16_bf16 v[64:79], v[44:47], v[140:143], v[64:79]
ds_read_b128 v[36:39], v6 offset:9216
v_rcp_f32 v19, v19
v_mul_f32 v92, v92, v16
v_mul_f32 v93, v93, v17
v_mul_f32 v94, v94, v18
s_waitcnt lgkmcnt(4)
v_mfma_f32_32x32x16_bf16 v[64:79], v[48:51], v[144:147], v[64:79]
ds_read_b128 v[40:43], v6 offset:10240
v_mul_f32 v95, v95, v19
v_cvt_pk_bf16_f32 v106, v92, v93
v_cvt_pk_bf16_f32 v107, v94, v95
buffer_store_dwordx4 v[104:107], v1, s[44:47], s10 offen offset:512 sc1
v_mfma_f32_32x32x16_bf16 v[64:79], v[52:55], v[148:151], v[64:79]
ds_read_b128 v[44:47], v6 offset:11264
s_waitcnt lgkmcnt(4)
v_mfma_f32_32x32x16_bf16 v[64:79], v[56:59], v[152:155], v[64:79]
ds_read_b128 v[48:51], v6 offset:12288
v_mfma_f32_32x32x16_bf16 v[64:79], v[60:63], v[156:159], v[64:79]
ds_read_b128 v[52:55], v6 offset:13312
s_waitcnt lgkmcnt(4)
v_mfma_f32_32x32x16_bf16 v[64:79], v[32:35], v[160:163], v[64:79]
ds_read_b128 v[56:59], v6 offset:14336
v_mfma_f32_32x32x16_bf16 v[64:79], v[36:39], v[164:167], v[64:79]
ds_read_b128 v[60:63], v6 offset:15360
s_barrier
s_waitcnt lgkmcnt(4)
v_mfma_f32_32x32x16_bf16 v[64:79], v[40:43], v[168:171], v[64:79]
ds_read_b128 v[32:35], v5
v_mfma_f32_32x32x16_bf16 v[64:79], v[44:47], v[172:175], v[64:79]
ds_read_b128 v[36:39], v5 offset:1024
s_waitcnt lgkmcnt(4)
v_mfma_f32_32x32x16_bf16 v[64:79], v[48:51], v[176:179], v[64:79]
ds_read_b128 v[40:43], v5 offset:2048
v_mfma_f32_32x32x16_bf16 v[64:79], v[52:55], v[180:183], v[64:79]
ds_read_b128 v[44:47], v5 offset:3072
s_waitcnt lgkmcnt(4)
v_mfma_f32_32x32x16_bf16 v[64:79], v[56:59], v[184:187], v[64:79]
ds_read_b128 v[48:51], v5 offset:4096
v_mfma_f32_32x32x16_bf16 v[64:79], v[60:63], v[188:191], v[64:79]
ds_read_b128 v[52:55], v5 offset:5120
s_waitcnt lgkmcnt(4)
v_mfma_f32_32x32x16_bf16 v[64:79], v[32:35], v[192:195], v[64:79]
ds_read_b128 v[56:59], v5 offset:6144
v_mfma_f32_32x32x16_bf16 v[64:79], v[36:39], v[196:199], v[64:79]
ds_read_b128 v[60:63], v5 offset:7168
s_waitcnt lgkmcnt(4)
v_mfma_f32_32x32x16_bf16 v[64:79], v[40:43], v[200:203], v[64:79]
ds_read_b128 v[32:35], v5 offset:8192
v_mfma_f32_32x32x16_bf16 v[64:79], v[44:47], v[204:207], v[64:79]
ds_read_b128 v[36:39], v5 offset:9216
s_waitcnt lgkmcnt(4)
v_mfma_f32_32x32x16_bf16 v[64:79], v[48:51], v[208:211], v[64:79]
ds_read_b128 v[40:43], v5 offset:10240
v_mfma_f32_32x32x16_bf16 v[64:79], v[52:55], v[212:215], v[64:79]
ds_read_b128 v[44:47], v5 offset:11264
s_waitcnt lgkmcnt(4)
v_mfma_f32_32x32x16_bf16 v[64:79], v[56:59], v[216:219], v[64:79]
ds_read_b128 v[48:51], v5 offset:12288
v_mfma_f32_32x32x16_bf16 v[64:79], v[60:63], v[220:223], v[64:79]
ds_read_b128 v[52:55], v5 offset:13312
s_waitcnt lgkmcnt(4)
v_mfma_f32_32x32x16_bf16 v[64:79], v[32:35], v[224:227], v[64:79]
ds_read_b128 v[56:59], v5 offset:14336
v_mfma_f32_32x32x16_bf16 v[64:79], v[36:39], v[228:231], v[64:79]
ds_read_b128 v[60:63], v5 offset:15360
s_barrier
s_waitcnt lgkmcnt(4)
v_mfma_f32_32x32x16_bf16 v[64:79], v[40:43], v[232:235], v[64:79]
ds_read_b128 v[32:35], v5 offset:16384
v_mfma_f32_32x32x16_bf16 v[64:79], v[44:47], v[236:239], v[64:79]
ds_read_b128 v[36:39], v5 offset:17408
s_waitcnt lgkmcnt(4)
v_mfma_f32_32x32x16_bf16 v[64:79], v[48:51], v[240:243], v[64:79]
ds_read_b128 v[40:43], v5 offset:18432
v_mfma_f32_32x32x16_bf16 v[64:79], v[52:55], v[244:247], v[64:79]
ds_read_b128 v[44:47], v5 offset:19456
s_waitcnt lgkmcnt(4)
v_mfma_f32_32x32x16_bf16 v[64:79], v[56:59], v[248:251], v[64:79]
ds_read_b128 v[48:51], v5 offset:20480
v_mfma_f32_32x32x16_bf16 v[64:79], v[60:63], v[252:255], v[64:79]
ds_read_b128 v[52:55], v5 offset:21504
s_waitcnt lgkmcnt(4)
v_mfma_f32_32x32x16_bf16 v[80:95], v[32:35], v[128:131], 0
ds_read_b128 v[56:59], v5 offset:22528
v_mfma_f32_32x32x16_bf16 v[80:95], v[36:39], v[132:135], v[80:95]
ds_read_b128 v[60:63], v5 offset:23552
v_mul_f32 v12, s57, v112
v_mul_f32 v13, s57, v113
v_mul_f32 v14, s57, v114
v_mul_f32 v15, s57, v115
v_exp_f32 v12, v12
s_nop 0
v_mul_f32 v112, v112, v64
s_waitcnt lgkmcnt(4)
v_mfma_f32_32x32x16_bf16 v[80:95], v[40:43], v[136:139], v[80:95]
ds_read_b128 v[32:35], v5 offset:24576
v_exp_f32 v13, v13
v_mul_f32 v113, v113, v65
v_exp_f32 v14, v14
v_mul_f32 v114, v114, v66
v_exp_f32 v15, v15
v_mfma_f32_32x32x16_bf16 v[80:95], v[44:47], v[140:143], v[80:95]
ds_read_b128 v[36:39], v5 offset:25600
v_mul_f32 v115, v115, v67
v_fma_f32 v12, v12, v8, v8
v_fma_f32 v13, v13, v8, v8
v_fma_f32 v14, v14, v8, v8
v_fma_f32 v15, v15, v8, v8
v_rcp_f32 v12, v12
s_waitcnt lgkmcnt(4)
v_mfma_f32_32x32x16_bf16 v[80:95], v[48:51], v[144:147], v[80:95]
ds_read_b128 v[40:43], v5 offset:26624
v_rcp_f32 v13, v13
v_rcp_f32 v14, v14
v_rcp_f32 v15, v15
v_mul_f32 v112, v112, v12
v_mul_f32 v113, v113, v13
v_mfma_f32_32x32x16_bf16 v[80:95], v[52:55], v[148:151], v[80:95]
ds_read_b128 v[44:47], v5 offset:27648
v_mul_f32 v114, v114, v14
v_mul_f32 v115, v115, v15
v_cvt_pk_bf16_f32 v64, v112, v113
v_cvt_pk_bf16_f32 v65, v114, v115
v_mul_f32 v16, s57, v116
v_mul_f32 v17, s57, v117
v_mul_f32 v18, s57, v118
v_mul_f32 v19, s57, v119
s_waitcnt lgkmcnt(4)
v_mfma_f32_32x32x16_bf16 v[80:95], v[56:59], v[152:155], v[80:95]
ds_read_b128 v[48:51], v5 offset:28672
v_exp_f32 v16, v16
v_mul_f32 v116, v116, v68
v_exp_f32 v17, v17
v_mul_f32 v117, v117, v69
v_exp_f32 v18, v18
v_mfma_f32_32x32x16_bf16 v[80:95], v[60:63], v[156:159], v[80:95]
ds_read_b128 v[52:55], v5 offset:29696
v_mul_f32 v118, v118, v70
v_exp_f32 v19, v19
v_mul_f32 v119, v119, v71
v_fma_f32 v16, v16, v8, v8
v_fma_f32 v17, v17, v8, v8
v_fma_f32 v18, v18, v8, v8
v_fma_f32 v19, v19, v8, v8
s_waitcnt lgkmcnt(4)
v_mfma_f32_32x32x16_bf16 v[80:95], v[32:35], v[160:163], v[80:95]
ds_read_b128 v[56:59], v5 offset:30720
v_rcp_f32 v16, v16
v_rcp_f32 v17, v17
v_rcp_f32 v18, v18
v_mfma_f32_32x32x16_bf16 v[80:95], v[36:39], v[164:167], v[80:95]
ds_read_b128 v[60:63], v5 offset:31744
v_rcp_f32 v19, v19
v_mul_f32 v116, v116, v16
v_mul_f32 v117, v117, v17
v_mul_f32 v118, v118, v18
v_mul_f32 v119, v119, v19
v_cvt_pk_bf16_f32 v66, v116, v117
v_cvt_pk_bf16_f32 v67, v118, v119
s_add_u32 s10, s67, 0xc000
s_barrier
s_waitcnt lgkmcnt(4)
v_mfma_f32_32x32x16_bf16 v[80:95], v[40:43], v[168:171], v[80:95]
ds_read_b128 v[32:35], v5 offset:32768
buffer_store_dwordx4 v[64:67], v1, s[44:47], s10 offen sc1
v_mul_f32 v12, s57, v120
v_mul_f32 v13, s57, v121
v_mul_f32 v14, s57, v122
v_mul_f32 v15, s57, v123
v_exp_f32 v12, v12
v_mul_f32 v120, v120, v72
v_mfma_f32_32x32x16_bf16 v[80:95], v[44:47], v[172:175], v[80:95]
ds_read_b128 v[36:39], v5 offset:33792
v_exp_f32 v13, v13
v_mul_f32 v121, v121, v73
v_exp_f32 v14, v14
v_mul_f32 v122, v122, v74
s_waitcnt lgkmcnt(4)
v_mfma_f32_32x32x16_bf16 v[80:95], v[48:51], v[176:179], v[80:95]
ds_read_b128 v[40:43], v5 offset:34816
v_exp_f32 v15, v15
v_mul_f32 v123, v123, v75
v_fma_f32 v12, v12, v8, v8
v_fma_f32 v13, v13, v8, v8
v_fma_f32 v14, v14, v8, v8
v_fma_f32 v15, v15, v8, v8
v_rcp_f32 v12, v12
v_mfma_f32_32x32x16_bf16 v[80:95], v[52:55], v[180:183], v[80:95]
ds_read_b128 v[44:47], v5 offset:35840
v_rcp_f32 v13, v13
v_rcp_f32 v14, v14
v_rcp_f32 v15, v15
v_mul_f32 v120, v120, v12
v_mul_f32 v121, v121, v13
s_waitcnt lgkmcnt(4)
v_mfma_f32_32x32x16_bf16 v[80:95], v[56:59], v[184:187], v[80:95]
ds_read_b128 v[48:51], v5 offset:36864
v_mul_f32 v122, v122, v14
v_mul_f32 v123, v123, v15
v_cvt_pk_bf16_f32 v72, v120, v121
v_cvt_pk_bf16_f32 v73, v122, v123
v_mul_f32 v16, s57, v124
v_mul_f32 v17, s57, v125
v_mul_f32 v18, s57, v126
v_mul_f32 v19, s57, v127
v_mfma_f32_32x32x16_bf16 v[80:95], v[60:63], v[188:191], v[80:95]
ds_read_b128 v[52:55], v5 offset:37888
v_exp_f32 v16, v16
v_mul_f32 v124, v124, v76
v_exp_f32 v17, v17
v_mul_f32 v125, v125, v77
s_waitcnt lgkmcnt(4)
v_mfma_f32_32x32x16_bf16 v[80:95], v[32:35], v[192:195], v[80:95]
ds_read_b128 v[56:59], v5 offset:38912
v_exp_f32 v18, v18
v_mul_f32 v126, v126, v78
v_exp_f32 v19, v19
v_mul_f32 v127, v127, v79
v_fma_f32 v16, v16, v8, v8
v_fma_f32 v17, v17, v8, v8
v_fma_f32 v18, v18, v8, v8
v_mfma_f32_32x32x16_bf16 v[80:95], v[36:39], v[196:199], v[80:95]
ds_read_b128 v[60:63], v5 offset:39936
v_fma_f32 v19, v19, v8, v8
v_rcp_f32 v16, v16
v_rcp_f32 v17, v17
v_rcp_f32 v18, v18
s_waitcnt lgkmcnt(4)
v_mfma_f32_32x32x16_bf16 v[80:95], v[40:43], v[200:203], v[80:95]
ds_read_b128 v[32:35], v5 offset:40960
v_rcp_f32 v19, v19
v_mul_f32 v124, v124, v16
v_mul_f32 v125, v125, v17
v_mul_f32 v126, v126, v18
v_mul_f32 v127, v127, v19
v_cvt_pk_bf16_f32 v74, v124, v125
v_cvt_pk_bf16_f32 v75, v126, v127
buffer_store_dwordx4 v[72:75], v1, s[44:47], s10 offen offset:512 sc1
v_mfma_f32_32x32x16_bf16 v[80:95], v[44:47], v[204:207], v[80:95]
ds_read_b128 v[36:39], v5 offset:41984
s_waitcnt lgkmcnt(4)
v_mfma_f32_32x32x16_bf16 v[80:95], v[48:51], v[208:211], v[80:95]
ds_read_b128 v[40:43], v5 offset:43008
v_mfma_f32_32x32x16_bf16 v[80:95], v[52:55], v[212:215], v[80:95]
ds_read_b128 v[44:47], v5 offset:44032
s_waitcnt lgkmcnt(4)
v_mfma_f32_32x32x16_bf16 v[80:95], v[56:59], v[216:219], v[80:95]
ds_read_b128 v[48:51], v5 offset:45056
v_mfma_f32_32x32x16_bf16 v[80:95], v[60:63], v[220:223], v[80:95]
ds_read_b128 v[52:55], v5 offset:46080
s_waitcnt lgkmcnt(4)
v_mfma_f32_32x32x16_bf16 v[80:95], v[32:35], v[224:227], v[80:95]
ds_read_b128 v[56:59], v5 offset:47104
v_mfma_f32_32x32x16_bf16 v[80:95], v[36:39], v[228:231], v[80:95]
ds_read_b128 v[60:63], v5 offset:48128
s_barrier
s_waitcnt lgkmcnt(4)
v_mfma_f32_32x32x16_bf16 v[80:95], v[40:43], v[232:235], v[80:95]
v_mfma_f32_32x32x16_bf16 v[80:95], v[44:47], v[236:239], v[80:95]
s_waitcnt lgkmcnt(2)
v_mfma_f32_32x32x16_bf16 v[80:95], v[48:51], v[240:243], v[80:95]
v_mfma_f32_32x32x16_bf16 v[80:95], v[52:55], v[244:247], v[80:95]
s_waitcnt lgkmcnt(0)
v_mfma_f32_32x32x16_bf16 v[80:95], v[56:59], v[248:251], v[80:95]
v_mfma_f32_32x32x16_bf16 v[80:95], v[60:63], v[252:255], v[80:95]
s_barrier
s_nop 10
v_mul_f32 v12, s57, v80
v_mul_f32 v16, s57, v84
v_mul_f32 v13, s57, v81
v_mul_f32 v17, s57, v85
v_mul_f32 v14, s57, v82
v_mul_f32 v18, s57, v86
v_mul_f32 v15, s57, v83
v_mul_f32 v19, s57, v87
v_exp_f32 v12, v12
v_exp_f32 v16, v16
v_mul_f32 v80, v80, v88
v_mul_f32 v84, v84, v92
v_exp_f32 v13, v13
v_exp_f32 v17, v17
v_mul_f32 v81, v81, v89
v_mul_f32 v85, v85, v93
v_exp_f32 v14, v14
v_exp_f32 v18, v18
v_mul_f32 v82, v82, v90
v_mul_f32 v86, v86, v94
v_exp_f32 v15, v15
v_exp_f32 v19, v19
v_mul_f32 v83, v83, v91
v_mul_f32 v87, v87, v95
v_fma_f32 v12, v12, v8, v8
v_fma_f32 v16, v16, v8, v8
v_fma_f32 v13, v13, v8, v8
v_fma_f32 v17, v17, v8, v8
v_fma_f32 v14, v14, v8, v8
v_fma_f32 v18, v18, v8, v8
v_fma_f32 v15, v15, v8, v8
v_fma_f32 v19, v19, v8, v8
v_rcp_f32 v12, v12
v_rcp_f32 v16, v16
v_rcp_f32 v13, v13
v_rcp_f32 v17, v17
v_rcp_f32 v14, v14
v_rcp_f32 v18, v18
v_rcp_f32 v15, v15
v_rcp_f32 v19, v19
v_mul_f32 v80, v80, v12
v_mul_f32 v84, v84, v16
v_mul_f32 v81, v81, v13
v_mul_f32 v85, v85, v17
v_mul_f32 v82, v82, v14
v_mul_f32 v86, v86, v18
v_mul_f32 v83, v83, v15
v_mul_f32 v87, v87, v19
v_cvt_pk_bf16_f32 v24, v80, v81
v_cvt_pk_bf16_f32 v26, v84, v85
v_cvt_pk_bf16_f32 v25, v82, v83
v_cvt_pk_bf16_f32 v27, v86, v87
buffer_store_dwordx4 v[24:27], v1, s[44:47], s68 offen sc1
s_endpgm
.p2align 6
L_B:
s_setprio 3
v_lshrrev_b32 v16, 5, v0
v_lshlrev_b32 v16, 1, v16
v_and_b32 v17, 3, v0
v_xor_b32 v16, v16, v17
v_lshlrev_b32 v16, 4, v16
v_lshrrev_b32 v17, 2, v0
v_mul_u32_u24 v18, 0xc00, v17
v_add_u32 v108, v16, v18
v_mul_u32_u24 v18, 0xe00, v17
v_add_u32 v109, v16, v18
s_lshl_b32 s9, s60, 1
s_add_u32 s9, s9, s4
s_lshl_b32 s9, s9, 1
s_and_b32 s67, s9, 15
s_xor_b32 s68, s67, 8
s_lshl_b32 s9, s6, 6
s_mul_i32 s63, s67, 0x18000
s_add_u32 s63, s63, s9
s_mul_i32 s64, s68, 0x18000
s_add_u32 s64, s64, s9
s_lshl_b32 s75, s4, 12
s_add_u32 s75, s75, 0x14000
s_lshl_b32 s9, s2, 2
s_add_u32 s9, s9, s4
s_mul_i32 s10, s9, 0x600
v_lshlrev_b32 v216, 7, v0
v_cmp_gt_u32 vcc, 12, v0
v_mov_b32 v217, 0x40000000
s_nop 0
v_cndmask_b32 v216, v217, v216, vcc
s_waitcnt lgkmcnt(0)
buffer_load_dword v218, v216, s[16:19], s10 offen
s_or_b32 s9, s2, s4
s_cmp_eq_u32 s9, 0
s_cselect_b32 s81, 0, 0x40000000
s_cmp_lg_u32 s2, 0
s_cbranch_scc1 L_noinit
v_lshlrev_b32 v13, 8, v0
v_mov_b32 v12, 0
s_lshl_b32 s10, s4, 14
s_mov_b32 s11, 0x10000
buffer_store_dword v12, v13, s[44:47], s10 offen sc1
buffer_store_dword v12, v13, s[44:47], s11 offen sc1
L_noinit:
s_add_u32 m0, s75, 0xc000
s_add_u32 s76, s63, 0x400
buffer_load_dwordx4 v108, s[16:19], s76 offen lds
s_add_u32 m0, s75, 0xc400
s_add_u32 s77, s63, 0xc400
buffer_load_dwordx4 v108, s[16:19], s77 offen lds
s_add_u32 m0, s75, 0xc800
s_add_u32 s76, s63, 0x18400
buffer_load_dwordx4 v108, s[16:19], s76 offen lds
s_add_u32 m0, s75, 0xcc00
s_add_u32 s77, s63, 0x24400
buffer_load_dwordx4 v108, s[16:19], s77 offen lds
v_lshrrev_b32 v16, 4, v0
v_and_b32 v17, 7, v0
v_xor_b32 v16, v16, v17
v_lshlrev_b32 v16, 4, v16
v_lshrrev_b32 v17, 3, v0
v_lshlrev_b32 v17, 10, v17
v_add_u32 v224, v16, v17
v_xor_b32 v225, 64, v224
v_add_u32 v226, 0x3800, v224
v_add_u32 v225, 0x1c00, v225
v_add_u32 v227, 0x3800, v225
s_lshl_b32 s86, s5, 7
s_lshl_b32 s9, s4, 5
s_add_u32 s86, s86, s9
s_lshl_b32 s86, s86, 10
s_add_u32 s84, s60, 2
s_and_b32 s84, s84, 3
s_lshl_b32 s84, s84, 8
s_add_u32 s84, s84, s86
s_add_u32 s85, s60, 3
s_and_b32 s85, s85, 3
s_lshl_b32 s85, s85, 8
s_add_u32 s85, s85, s86
s_lshl_b32 s9, s4, 13
s_add_u32 s82, s9, 0
s_add_u32 s83, s9, 0x8000
v_cmp_eq_u32 vcc, 0, v0
v_mov_b32 v6, 0x7ffffff0
s_nop 0
v_cndmask_b32 v6, v6, 0, vcc
v_add_u32 v13, s81, v6
v_mov_b32 v12, 1
v_lshlrev_b32 v1, 4, v0
s_mul_i32 s9, s6, 0xc0
s_mul_i32 s65, s67, 0x1c000
s_add_u32 s65, s65, s9
s_mul_i32 s66, s68, 0x1c000
s_add_u32 s66, s66, s9
s_lshr_b32 s88, s2, 5
s_and_b32 s89, s2, 31
v_lshrrev_b32 v16, 3, v0
v_and_b32 v17, 7, v0
v_lshlrev_b32 v17, 4, v17
v_mul_u32_u24 v18, 0xe00, v16
v_add_u32 v209, v18, v17
s_mul_i32 s9, s88, 3
s_add_u32 s9, s9, s4
s_lshr_b32 s10, s88, 1
s_add_u32 s10, s10, 24
s_cmp_eq_u32 s4, 3
s_cselect_b32 s9, s10, s9
s_lshl_b32 s90, s9, 7
s_mul_i32 s9, s89, 0xe000
s_add_u32 s90, s90, s9
s_lshl_b32 s95, s4, 14
s_cmp_eq_u32 s4, 0
s_cselect_b32 s9, 0, 0x40000000
v_add_u32 v212, s9, v6
v_lshrrev_b32 v16, 5, v0
v_lshlrev_b32 v16, 10, v16
v_bfe_u32 v17, v0, 2, 2
v_lshlrev_b32 v17, 7, v17
v_add_u32 v16, v16, v17
v_and_b32 v17, 3, v0
v_lshlrev_b32 v17, 3, v17
v_add_u32 v16, v16, v17
v_add_u32 v16, s95, v16
s_cmp_eq_u32 s4, 3
s_cselect_b32 s9, 11, 5
v_bfe_u32 v17, v0, 4, 1
v_lshlrev_b32 v17, s9, v17
v_add_u32 v16, v16, v17
s_and_b32 s10, s88, 1
s_lshl_b32 s10, s10, 6
s_cselect_b32 s10, s10, 0
s_cmp_eq_u32 s4, 3
s_cselect_b32 s10, s10, 0
s_cselect_b32 s11, 32, 64
v_add_u32 v210, s10, v16
v_add_u32 v211, s11, v210
s_mul_i32 s78, s88, 0xa0000
s_lshl_b32 s9, s89, 10
s_add_u32 s78, s78, s9
s_add_u32 s78, s78, 0x1000000
s_lshl_b32 s9, s4, 1
s_add_u32 s9, s9, 0
s_lshl_b32 s10, s9, 16
s_add_u32 s10, s10, 0x18000
s_add_u32 s11, s10, 0x20000
s_cmp_ge_u32 s9, 3
s_cselect_b32 s10, s11, s10
s_add_u32 s91, s78, s10
s_add_u32 s93, s91, 0x8000
s_lshl_b32 s9, s4, 1
s_add_u32 s9, s9, 1
s_lshl_b32 s10, s9, 16
s_add_u32 s10, s10, 0x18000
s_add_u32 s11, s10, 0x20000
s_cmp_ge_u32 s9, 3
s_cselect_b32 s10, s11, s10
s_add_u32 s92, s78, s10
s_add_u32 s94, s92, 0x8000
s_lshl_b32 s9, s2, 10
s_add_u32 s9, s9, 0x1500000
s_add_u32 s10, s78, 0x48000
s_add_u32 s11, s10, 0x50000
s_cmp_eq_u32 s4, 3
s_cselect_b32 s93, s9, s93
s_cselect_b32 s94, s9, s94
s_cselect_b32 s91, s10, s91
s_cselect_b32 s92, s11, s92
s_lshl_b32 s80, s88, 1
s_and_b32 s9, s89, 1
s_add_u32 s80, s80, s9
s_lshl_b32 s80, s80, 9
s_add_u32 s80, s80, 0xc000
s_lshr_b32 s9, s6, 1
s_lshl_b32 s9, s9, 10
s_add_u32 s9, s9, 0xc000
v_and_b32 v16, 1, v0
v_lshlrev_b32 v16, 9, v16
v_add_u32 v111, s9, v16
s_mul_i32 s9, s6, 0x50000
s_add_u32 s9, s9, 0x1000000
s_lshl_b32 s67, s67, 11
s_add_u32 s67, s67, s9
s_lshl_b32 s68, s68, 11
s_add_u32 s68, s68, s9
s_waitcnt vmcnt(0)
s_barrier
v_lshrrev_b32 v16, 3, v0
v_lshlrev_b32 v16, 12, v16
v_and_b32 v17, 7, v0
v_lshlrev_b32 v17, 4, v17
v_add_u32 v2, v16, v17
s_add_u32 m0, s75, 0x10000
s_add_u32 s76, s64, 0x400
buffer_load_dwordx4 v108, s[16:19], s76 offen lds
v_xor_b32 v3, 32, v2
v_xor_b32 v4, 64, v2
v_xor_b32 v14, 0x60, v2
v_bfe_u32 v16, v0, 2, 2
v_mul_u32_u24 v16, 0x420, v16
s_add_u32 m0, s75, 0x10400
s_add_u32 s77, s64, 0xc400
buffer_load_dwordx4 v108, s[16:19], s77 offen lds
v_lshrrev_b32 v17, 4, v0
v_lshlrev_b32 v17, 7, v17
v_add_u32 v16, v16, v17
v_and_b32 v17, 3, v0
v_lshlrev_b32 v17, 3, v17
s_add_u32 m0, s75, 0x10800
s_add_u32 s76, s64, 0x18400
buffer_load_dwordx4 v108, s[16:19], s76 offen lds
v_add_u32 v5, v16, v17
v_lshrrev_b32 v17, 5, v0
v_lshlrev_b32 v17, 8, v17
v_add_u32 v7, v5, v17
v_and_b32 v16, 15, v0
s_add_u32 m0, s75, 0x10c00
s_add_u32 s77, s64, 0x24400
buffer_load_dwordx4 v108, s[16:19], s77 offen lds
v_bfe_u32 v17, v0, 4, 1
v_lshlrev_b32 v17, 5, v17
v_add_u32 v16, v16, v17
v_lshlrev_b32 v16, 4, v16
v_lshrrev_b32 v17, 5, v0
s_add_u32 m0, s82, 0
s_add_u32 s76, s84, 0
buffer_load_dwordx4 v224, s[12:15], s76 offen lds
v_lshlrev_b32 v17, 3, v17
v_add_u32 v16, v16, v17
s_lshl_b32 s62, s4, 14
s_lshl_b32 s9, s4, 11
s_add_u32 s9, s9, 0x10000
buffer_load_dwordx4 v225, s[12:15], s76 offen offset:1024 lds
v_add_u32 v110, s9, v16
v_add_u32 v112, s62, v7
v_xor_b32 v113, 32, v112
v_xor_b32 v114, 64, v112
v_xor_b32 v115, 0x60, v112
buffer_load_dwordx4 v226, s[12:15], s76 offen offset:2048 lds
v_lshrrev_b32 v16, 4, v0
v_lshlrev_b32 v16, 2, v16
v_and_b32 v17, 15, v0
v_sub_u32 v16, v17, v16
v_mov_b32 v18, 0x3f80
buffer_load_dwordx4 v227, s[12:15], s76 offen offset:3072 lds
v_mov_b32 v19, 0x3f800000
v_mov_b32 v22, 0
v_cmp_eq_u32 vcc, 0, v16
s_nop 1
v_cndmask_b32 v22, v22, v18, vcc
v_cmp_eq_u32 vcc, 1, v16
s_add_u32 m0, s82, 0x1000
s_add_u32 s77, s84, 0x80
buffer_load_dwordx4 v224, s[12:15], s77 offen lds
v_cndmask_b32 v22, v22, v19, vcc
v_mov_b32 v26, v22
v_mov_b32 v24, 0
v_mov_b32 v23, 0
v_cmp_eq_u32 vcc, 2, v16
buffer_load_dwordx4 v225, s[12:15], s77 offen offset:1024 lds
s_nop 0
v_cndmask_b32 v23, v23, v18, vcc
v_cmp_eq_u32 vcc, 3, v16
s_nop 1
v_cndmask_b32 v23, v23, v19, vcc
v_mov_b32 v27, v23
v_mov_b32 v25, 0
buffer_load_dwordx4 v226, s[12:15], s77 offen offset:2048 lds
v_mov_b32 v28, 0x3f803f80
v_mov_b32 v29, 0x3f803f80
v_mov_b32 v30, 0x3f803f80
v_mov_b32 v31, 0x3f803f80
s_lshr_b32 s9, s4, 1
buffer_load_dwordx4 v227, s[12:15], s77 offen offset:3072 lds
s_lshl_b32 s10, s5, 1
s_add_u32 s10, s10, s9
s_mul_i32 s69, s10, 0x48
s_lshr_b32 s11, s6, 2
s_mul_i32 s11, s11, 18
s_add_u32 m0, s83, 0
s_add_u32 s76, s85, 0
buffer_load_dwordx4 v224, s[12:15], s76 offen lds
s_add_u32 s69, s69, s11
s_lshl_b32 s69, s69, 12
s_add_u32 s69, s69, 0x200000
s_and_b32 s11, s6, 3
s_lshr_b32 s10, s11, 1
buffer_load_dwordx4 v225, s[12:15], s76 offen offset:1024 lds
s_add_u32 s10, s10, 16
s_lshl_b32 s10, s10, 12
s_add_u32 s70, s69, s10
s_and_b32 s10, s6, 1
s_lshl_b32 s10, s10, 9
buffer_load_dwordx4 v226, s[12:15], s76 offen offset:2048 lds
s_add_u32 s70, s70, s10
s_and_b32 s10, s4, 1
s_lshl_b32 s10, s10, 11
s_add_u32 s70, s70, s10
s_lshl_b32 s11, s11, 12
buffer_load_dwordx4 v227, s[12:15], s76 offen offset:3072 lds
s_add_u32 s69, s69, s11
s_add_u32 s69, s69, s10
s_lshl_b32 s71, s5, 2
s_lshr_b32 s10, s6, 2
s_add_u32 s71, s71, s10
s_add_u32 m0, s83, 0x1000
s_add_u32 s77, s85, 0x80
buffer_load_dwordx4 v224, s[12:15], s77 offen lds
s_lshl_b32 s71, s71, 1
s_add_u32 s71, s71, s9
s_lshl_b32 s71, s71, 8
s_add_u32 s71, s71, 0
s_mul_i32 s79, s7, 0x48
buffer_load_dwordx4 v225, s[12:15], s77 offen offset:1024 lds
s_mul_i32 s9, s4, 18
s_add_u32 s79, s79, s9
s_lshl_b32 s79, s79, 12
s_add_u32 s79, s79, 0x200000
s_lshr_b32 s72, s7, 1
buffer_load_dwordx4 v226, s[12:15], s77 offen offset:2048 lds
s_lshl_b32 s72, s72, 2
s_add_u32 s72, s72, s4
s_lshl_b32 s72, s72, 1
s_and_b32 s9, s7, 1
s_add_u32 s72, s72, s9
buffer_load_dwordx4 v227, s[12:15], s77 offen offset:3072 lds
s_lshl_b32 s72, s72, 8
s_add_u32 s72, s72, 0
s_lshl_b32 s74, s6, 2
s_add_u32 s74, s74, s4
s_lshl_b32 s73, s74, 14
s_add_u32 s73, s73, 0x40000
s_lshl_b32 s74, s74, 8
s_add_u32 s74, s74, 0x8000
s_waitcnt vmcnt(16)
s_waitcnt vmcnt(8)
s_barrier
s_setprio 0
buffer_store_dword v12, v13, s[52:55], 0 offen sc1
s_add_u32 m0, s75, 0
s_add_u32 s76, s63, 0x800
buffer_load_dwordx4 v108, s[16:19], s76 offen lds
s_add_u32 m0, s75, 0x400
s_add_u32 s77, s63, 0xc800
buffer_load_dwordx4 v108, s[16:19], s77 offen lds
s_add_u32 m0, s75, 0x800
s_add_u32 s76, s63, 0x18800
buffer_load_dwordx4 v108, s[16:19], s76 offen lds
s_add_u32 m0, s75, 0xc00
s_add_u32 s77, s63, 0x24800
buffer_load_dwordx4 v108, s[16:19], s77 offen lds
s_lshl_b32 s9, s6, 10
s_add_u32 s36, s36, s9
s_addc_u32 s37, s37, 0
s_cmp_eq_u32 s4, 0
s_cselect_b32 s36, s40, s36
s_cselect_b32 s37, s41, s37
s_mov_b32 s9, 0x13800
s_cselect_b32 s9, 0x13000, s9
s_cmp_ge_u32 s4, 2
s_cselect_b32 s38, 0, 0x400
s_cselect_b32 m0, 0x13400, s9
s_nop 0
buffer_load_dwordx4 v1, s[36:39], 0 offen lds
s_waitcnt vmcnt(6)
s_barrier
s_add_u32 s86, s7, s8
s_and_b32 s86, s86, 3
s_lshl_b32 s11, s8, 7
s_add_u32 s9, s86, 0
s_and_b32 s9, s9, 3
s_lshl_b32 s40, s9, 12
s_add_u32 m0, s75, 0x4000
s_add_u32 s76, s64, 0x800
buffer_load_dwordx4 v108, s[16:19], s76 offen lds
s_add_u32 s40, s40, s79
s_lshl_b32 s10, s4, 2
s_add_u32 s9, s9, s10
s_mul_i32 s12, s9, 0x18000
s_add_u32 s12, s12, s11
s_lshl_b32 s36, s9, 15
s_add_u32 m0, s75, 0x4400
s_add_u32 s77, s64, 0xc800
buffer_load_dwordx4 v108, s[16:19], s77 offen lds
s_add_u32 s36, s36, s11
s_add_u32 s9, s86, 1
s_and_b32 s9, s9, 3
s_lshl_b32 s41, s9, 12
s_add_u32 s41, s41, s79
s_lshl_b32 s10, s4, 2
s_add_u32 m0, s75, 0x4800
s_add_u32 s76, s64, 0x18800
buffer_load_dwordx4 v108, s[16:19], s76 offen lds
s_add_u32 s9, s9, s10
s_mul_i32 s13, s9, 0x18000
s_add_u32 s13, s13, s11
s_lshl_b32 s37, s9, 15
s_add_u32 s37, s37, s11
s_add_u32 s9, s86, 2
s_add_u32 m0, s75, 0x4c00
s_add_u32 s77, s64, 0x24800
buffer_load_dwordx4 v108, s[16:19], s77 offen lds
s_and_b32 s9, s9, 3
s_lshl_b32 s42, s9, 12
s_add_u32 s42, s42, s79
s_lshl_b32 s10, s4, 2
s_add_u32 s9, s9, s10
s_mul_i32 s14, s9, 0x18000
s_add_u32 s76, s90, 0
buffer_load_dwordx4 v[228:231], v209, s[20:23], s76 offen
s_add_u32 s14, s14, s11
s_lshl_b32 s38, s9, 15
s_add_u32 s38, s38, s11
s_add_u32 s9, s86, 3
s_and_b32 s9, s9, 3
s_lshl_b32 s43, s9, 12
s_add_u32 s77, s90, 0x7000
buffer_load_dwordx4 v[232:235], v209, s[20:23], s77 offen
s_add_u32 s43, s43, s79
s_lshl_b32 s10, s4, 2
s_add_u32 s9, s9, s10
s_mul_i32 s15, s9, 0x18000
s_add_u32 s15, s15, s11
s_lshl_b32 s39, s9, 15
s_add_u32 s76, s90, 0
buffer_load_dwordx4 v[236:239], v209, s[24:27], s76 offen
s_add_u32 s39, s39, s11
s_add_u32 s9, s86, 0
s_and_b32 s9, s9, 1
s_lshl_b32 s84, s9, 12
s_add_u32 s84, s84, s79
s_lshl_b32 s10, s4, 1
s_add_u32 s77, s90, 0x7000
buffer_load_dwordx4 v[240:243], v209, s[24:27], s77 offen
s_add_u32 s9, s9, s10
s_lshl_b32 s82, s9, 15
s_add_u32 s82, s82, s11
s_add_u32 s82, s82, 0x180000
s_add_u32 s9, s86, 1
s_and_b32 s9, s9, 1
s_lshl_b32 s85, s9, 12
s_add_u32 s85, s85, s79
s_lshl_b32 s10, s4, 1
s_add_u32 s9, s9, s10
s_lshl_b32 s83, s9, 15
s_add_u32 s83, s83, s11
s_add_u32 s83, s83, 0x180000
s_waitcnt vmcnt(9)
s_waitcnt vmcnt(8)
s_barrier
s_add_u32 m0, s75, 0x8000
s_add_u32 s76, s63, 0
buffer_load_dwordx4 v108, s[16:19], s76 offen lds
v_lshlrev_b32 v8, 3, v0
v_add_u32 v8, 0x13800, v8
ds_read_b64_tr_b16 v[16:17], v8
ds_read_b64_tr_b16 v[20:21], v8 offset:512
v_mov_b32 v18, 0
v_mov_b32 v19, 0
s_add_u32 m0, s75, 0x8400
s_add_u32 s77, s63, 0xc000
buffer_load_dwordx4 v108, s[16:19], s77 offen lds
s_add_u32 m0, s75, 0x8800
s_add_u32 s76, s63, 0x18000
buffer_load_dwordx4 v108, s[16:19], s76 offen lds
s_add_u32 m0, s75, 0x8c00
s_add_u32 s77, s63, 0x24000
buffer_load_dwordx4 v108, s[16:19], s77 offen lds
s_add_u32 m0, s75, 0xc000
s_add_u32 s76, s64, 0
buffer_load_dwordx4 v108, s[16:19], s76 offen lds
s_add_u32 m0, s75, 0xc400
s_add_u32 s77, s64, 0xc000
buffer_load_dwordx4 v108, s[16:19], s77 offen lds
s_add_u32 m0, s75, 0xc800
s_add_u32 s76, s64, 0x18000
buffer_load_dwordx4 v108, s[16:19], s76 offen lds
s_add_u32 m0, s75, 0xcc00
s_add_u32 s77, s64, 0x24000
buffer_load_dwordx4 v108, s[16:19], s77 offen lds
s_waitcnt vmcnt(12)
s_barrier
s_waitcnt vmcnt(8)
v_add_u32 v209, s95, v1
ds_write_b128 v209, v[228:231] offset:2048
ds_write_b128 v209, v[232:235] offset:3072
ds_write_b128 v209, v[236:239] offset:4096
ds_write_b128 v209, v[240:243] offset:5120
ds_read_b64_tr_b16 v[192:193], v210 offset:2048
ds_read_b64_tr_b16 v[194:195], v210 offset:2560
ds_read_b64_tr_b16 v[196:197], v211 offset:2048
ds_read_b64_tr_b16 v[198:199], v211 offset:2560
ds_read_b64_tr_b16 v[200:201], v210 offset:4096
ds_read_b64_tr_b16 v[202:203], v210 offset:4608
ds_read_b64_tr_b16 v[204:205], v211 offset:4096
ds_read_b64_tr_b16 v[206:207], v211 offset:4608
s_waitcnt lgkmcnt(6)
buffer_store_dwordx4 v[192:195], v1, s[44:47], s91 offen sc1
s_waitcnt lgkmcnt(4)
buffer_store_dwordx4 v[196:199], v1, s[44:47], s92 offen sc1
s_waitcnt lgkmcnt(2)
buffer_store_dwordx4 v[200:203], v1, s[44:47], s93 offen sc1
s_waitcnt lgkmcnt(0)
buffer_store_dwordx4 v[204:207], v1, s[44:47], s94 offen sc1
buffer_load_dword v12, v6, s[52:55], 0 offen sc1
s_lshl_b32 s78, s2, 2
s_add_u32 s78, s78, s4
v_lshlrev_b32 v216, 7, v0
v_cmp_gt_u32 vcc, 14, v0
v_mov_b32 v217, 0x40000000
s_nop 0
v_cndmask_b32 v216, v217, v216, vcc
v_cmp_gt_u32 vcc, 4, v0
s_nop 1
v_cndmask_b32 v217, v217, v216, vcc
s_mul_i32 s76, s78, 0x700
s_lshl_b32 s77, s78, 9
buffer_load_dword v218, v216, s[28:31], s76 offen
buffer_load_dword v219, v217, s[32:35], s77 offen
s_add_u32 m0, s75, 0x10000
s_add_u32 s76, s65, 0
buffer_load_dwordx4 v109, s[20:23], s76 offen lds
ds_read_b64 v[32:33], v110
ds_read_b64 v[34:35], v110 offset:1024
ds_read_b64 v[36:37], v110 offset:256
ds_read_b64 v[38:39], v110 offset:1280
s_waitcnt lgkmcnt(2)
v_mfma_f32_16x16x32_bf16 v[40:43], v[16:19], v[32:35], 0
s_waitcnt lgkmcnt(0)
v_mfma_f32_16x16x32_bf16 v[44:47], v[16:19], v[36:39], 0
v_mfma_f32_16x16x32_bf16 v[48:51], v[18:21], v[32:35], 0
v_mfma_f32_16x16x32_bf16 v[52:55], v[18:21], v[36:39], 0
s_add_u32 m0, s75, 0x10400
s_add_u32 s77, s65, 0xe000
buffer_load_dwordx4 v109, s[20:23], s77 offen lds
s_nop 0
v_max3_f32 v72, v40, v41, v42
v_min3_f32 v76, v40, v41, v42
v_max3_f32 v73, v44, v45, v46
v_min3_f32 v77, v44, v45, v46
v_max3_f32 v74, v48, v49, v50
v_min3_f32 v78, v48, v49, v50
v_max3_f32 v75, v52, v53, v54
v_min3_f32 v79, v52, v53, v54
v_max_f32 v72, v72, v43
v_min_f32 v76, v76, v43
v_max_f32 v73, v73, v47
s_add_u32 m0, s75, 0x10800
s_add_u32 s76, s65, 0x1c000
buffer_load_dwordx4 v109, s[20:23], s76 offen lds
v_min_f32 v77, v77, v47
v_max_f32 v74, v74, v51
v_min_f32 v78, v78, v51
v_max_f32 v75, v75, v55
v_min_f32 v79, v79, v55
v_permlane16_swap_b32 v72, v73
v_permlane16_swap_b32 v76, v77
v_permlane16_swap_b32 v74, v75
v_permlane16_swap_b32 v78, v79
v_max_f32 v72, v72, v73
v_min_f32 v76, v76, v77
v_max_f32 v74, v74, v75
v_min_f32 v78, v78, v79
s_add_u32 m0, s75, 0x10c00
s_add_u32 s77, s65, 0x2a000
buffer_load_dwordx4 v109, s[20:23], s77 offen lds
v_permlane32_swap_b32 v72, v74
v_permlane32_swap_b32 v76, v78
v_max_f32 v72, v72, v74
v_min_f32 v76, v76, v78
v_mov_b32 v74, v72
v_mov_b32 v78, v76
s_nop 0
v_permlane32_swap_b32 v72, v74
v_permlane32_swap_b32 v76, v78
v_mov_b32 v73, v72
v_mov_b32 v77, v76
v_mov_b32 v75, v74
v_mov_b32 v79, v78
v_permlane16_swap_b32 v72, v73
v_permlane16_swap_b32 v76, v77
v_permlane16_swap_b32 v74, v75
v_permlane16_swap_b32 v78, v79
v_mul_f32 v72, s56, v72
v_mul_f32 v76, s56, v76
v_mul_f32 v73, s56, v73
v_mul_f32 v77, s56, v77
v_mul_f32 v74, s56, v74
v_mul_f32 v78, s56, v78
v_mul_f32 v75, s56, v75
v_mul_f32 v79, s56, v79
v_fma_f32 v56, v40, s57, v76
v_fma_f32 v40, v40, s56, -v72
v_fma_f32 v57, v41, s57, v76
v_fma_f32 v41, v41, s56, -v72
v_fma_f32 v58, v42, s57, v76
v_fma_f32 v42, v42, s56, -v72
v_fma_f32 v59, v43, s57, v76
v_fma_f32 v43, v43, s56, -v72
s_waitcnt vmcnt(15)
s_barrier
s_add_u32 m0, s75, 0
s_add_u32 s76, s66, 0
buffer_load_dwordx4 v109, s[20:23], s76 offen lds
v_exp_f32 v56, v56
v_exp_f32 v40, v40
v_exp_f32 v57, v57
v_exp_f32 v41, v41
v_exp_f32 v58, v58
s_add_u32 m0, s75, 0x400
s_add_u32 s77, s66, 0xe000
buffer_load_dwordx4 v109, s[20:23], s77 offen lds
v_exp_f32 v42, v42
v_exp_f32 v59, v59
v_exp_f32 v43, v43
v_fma_f32 v60, v44, s57, v77
v_fma_f32 v44, v44, s56, -v73
v_fma_f32 v61, v45, s57, v77
s_add_u32 m0, s75, 0x800
s_add_u32 s76, s66, 0x1c000
buffer_load_dwordx4 v109, s[20:23], s76 offen lds
v_fma_f32 v45, v45, s56, -v73
v_fma_f32 v62, v46, s57, v77
v_fma_f32 v46, v46, s56, -v73
v_fma_f32 v63, v47, s57, v77
v_fma_f32 v47, v47, s56, -v73
v_exp_f32 v60, v60
s_add_u32 m0, s75, 0xc00
s_add_u32 s77, s66, 0x2a000
buffer_load_dwordx4 v109, s[20:23], s77 offen lds
v_exp_f32 v44, v44
v_exp_f32 v61, v61
v_exp_f32 v45, v45
v_exp_f32 v62, v62
v_exp_f32 v46, v46
s_add_u32 m0, s62, 0
s_add_u32 s76, s12, 0
buffer_load_dwordx4 v2, s[28:31], s76 offen lds
v_exp_f32 v63, v63
v_exp_f32 v47, v47
v_fma_f32 v64, v48, s57, v78
v_fma_f32 v48, v48, s56, -v74
v_fma_f32 v65, v49, s57, v78
v_fma_f32 v49, v49, s56, -v74
buffer_load_dwordx4 v3, s[28:31], s76 offen offset:1024 lds
v_fma_f32 v66, v50, s57, v78
v_fma_f32 v50, v50, s56, -v74
v_fma_f32 v67, v51, s57, v78
v_fma_f32 v51, v51, s56, -v74
v_exp_f32 v64, v64
v_exp_f32 v48, v48
buffer_load_dwordx4 v4, s[28:31], s76 offen offset:2048 lds
v_exp_f32 v65, v65
v_exp_f32 v49, v49
v_exp_f32 v66, v66
v_exp_f32 v50, v50
v_exp_f32 v67, v67
buffer_load_dwordx4 v14, s[28:31], s76 offen offset:3072 lds
v_exp_f32 v51, v51
v_fma_f32 v68, v52, s57, v79
v_fma_f32 v52, v52, s56, -v75
v_fma_f32 v69, v53, s57, v79
v_fma_f32 v53, v53, s56, -v75
v_fma_f32 v70, v54, s57, v79
v_fma_f32 v54, v54, s56, -v75
v_fma_f32 v71, v55, s57, v79
v_fma_f32 v55, v55, s56, -v75
v_exp_f32 v68, v68
v_exp_f32 v52, v52
v_exp_f32 v69, v69
v_exp_f32 v53, v53
v_exp_f32 v70, v70
v_exp_f32 v54, v54
v_exp_f32 v71, v71
v_exp_f32 v55, v55
v_add_f32 v84, v40, v41
v_add_f32 v88, v56, v57
v_add_f32 v80, v42, v43
v_add_f32 v81, v58, v59
v_add_f32 v84, v84, v80
v_add_f32 v88, v88, v81
v_add_f32 v85, v44, v45
v_add_f32 v89, v60, v61
v_add_f32 v80, v46, v47
v_add_f32 v81, v62, v63
v_add_f32 v85, v85, v80
v_add_f32 v89, v89, v81
v_add_f32 v86, v48, v49
v_add_f32 v90, v64, v65
v_add_f32 v80, v50, v51
v_add_f32 v81, v66, v67
v_add_f32 v86, v86, v80
v_add_f32 v90, v90, v81
v_add_f32 v87, v52, v53
v_add_f32 v91, v68, v69
v_add_f32 v80, v54, v55
v_add_f32 v81, v70, v71
v_add_f32 v87, v87, v80
v_add_f32 v91, v91, v81
v_permlane16_swap_b32 v84, v85
v_permlane16_swap_b32 v88, v89
v_permlane16_swap_b32 v86, v87
s_waitcnt vmcnt(15)
s_barrier
s_waitcnt vmcnt(14)
v_readfirstlane_b32 s58, v12
s_nop 1
s_cmp_lg_u32 s58, 0
s_cbranch_scc1 L_Binit_ok
s_mov_b32 s59, 0x40000
L_Binit_spin:
buffer_load_dword v12, v6, s[52:55], 0 offen sc1
s_waitcnt vmcnt(0)
v_readfirstlane_b32 s58, v12
s_sub_u32 s59, s59, 1
s_cmp_eq_u32 s59, 0
s_cbranch_scc1 L_Binit_ok
s_cmp_lg_u32 s58, 0
s_cbranch_scc0 L_Binit_spin
L_Binit_ok:
v_mov_b32 v13, 1
buffer_atomic_add v13, v212, s[44:47], s80 offen sc1
ds_read_b64 v[32:33], v110
ds_read_b64 v[34:35], v110 offset:1024
ds_read_b64 v[36:37], v110 offset:256
ds_read_b64 v[38:39], v110 offset:1280
s_add_u32 m0, s75, 0x4000
s_add_u32 s77, s65, 0
buffer_load_dwordx4 v109, s[24:27], s77 offen lds
v_permlane16_swap_b32 v90, v91
v_add_f32 v84, v84, v85
v_add_f32 v88, v88, v89
v_add_f32 v86, v86, v87
v_add_f32 v90, v90, v91
s_nop 0
v_permlane32_swap_b32 v84, v86
v_permlane32_swap_b32 v88, v90
v_add_f32 v84, v84, v86
s_add_u32 m0, s75, 0x4400
s_add_u32 s76, s65, 0xe000
buffer_load_dwordx4 v109, s[24:27], s76 offen lds
v_add_f32 v88, v88, v90
v_mov_b32 v86, v84
v_mov_b32 v90, v88
s_nop 0
v_permlane32_swap_b32 v84, v86
v_permlane32_swap_b32 v88, v90
v_mov_b32 v85, v84
v_mov_b32 v89, v88
s_add_u32 m0, s75, 0x4800
s_add_u32 s77, s65, 0x1c000
buffer_load_dwordx4 v109, s[24:27], s77 offen lds
v_mov_b32 v87, v86
v_mov_b32 v91, v90
v_permlane16_swap_b32 v84, v85
v_permlane16_swap_b32 v88, v89
v_permlane16_swap_b32 v86, v87
v_permlane16_swap_b32 v90, v91
v_rcp_f32 v84, v84
s_add_u32 m0, s75, 0x4c00
s_add_u32 s76, s65, 0x2a000
buffer_load_dwordx4 v109, s[24:27], s76 offen lds
v_rcp_f32 v88, v88
v_rcp_f32 v85, v85
v_rcp_f32 v89, v89
v_rcp_f32 v86, v86
s_add_u32 m0, s62, 0x1000
s_add_u32 s77, s13, 0
buffer_load_dwordx4 v2, s[28:31], s77 offen lds
v_rcp_f32 v90, v90
v_rcp_f32 v87, v87
v_rcp_f32 v91, v91
v_mul_f32 v40, v40, v84
v_mul_f32 v56, v56, v88
v_mul_f32 v41, v41, v84
buffer_load_dwordx4 v3, s[28:31], s77 offen offset:1024 lds
v_mul_f32 v57, v57, v88
v_mul_f32 v42, v42, v84
v_mul_f32 v58, v58, v88
v_mul_f32 v43, v43, v84
v_mul_f32 v59, v59, v88
v_cvt_pk_bf16_f32 v92, v40, v41
v_cvt_pk_bf16_f32 v93, v42, v43
buffer_load_dwordx4 v4, s[28:31], s77 offen offset:2048 lds
v_cvt_pk_bf16_f32 v94, v56, v57
v_cvt_pk_bf16_f32 v95, v58, v59
v_mul_f32 v44, v44, v85
v_mul_f32 v60, v60, v89
v_mul_f32 v45, v45, v85
v_mul_f32 v61, v61, v89
v_mul_f32 v46, v46, v85
buffer_load_dwordx4 v14, s[28:31], s77 offen offset:3072 lds
v_mul_f32 v62, v62, v89
v_mul_f32 v47, v47, v85
v_mul_f32 v63, v63, v89
v_cvt_pk_bf16_f32 v96, v44, v45
v_cvt_pk_bf16_f32 v97, v46, v47
v_cvt_pk_bf16_f32 v98, v60, v61
v_cvt_pk_bf16_f32 v99, v62, v63
v_mul_f32 v48, v48, v86
v_mul_f32 v64, v64, v90
v_mul_f32 v49, v49, v86
v_mul_f32 v65, v65, v90
v_mul_f32 v50, v50, v86
v_mul_f32 v66, v66, v90
v_mul_f32 v51, v51, v86
v_mul_f32 v67, v67, v90
v_cvt_pk_bf16_f32 v100, v48, v49
v_cvt_pk_bf16_f32 v101, v50, v51
v_cvt_pk_bf16_f32 v102, v64, v65
v_cvt_pk_bf16_f32 v103, v66, v67
v_mul_f32 v52, v52, v87
v_mul_f32 v68, v68, v91
v_mul_f32 v53, v53, v87
v_mul_f32 v69, v69, v91
v_mul_f32 v54, v54, v87
v_mul_f32 v70, v70, v91
v_mul_f32 v55, v55, v87
v_mul_f32 v71, v71, v91
v_cvt_pk_bf16_f32 v104, v52, v53
v_cvt_pk_bf16_f32 v105, v54, v55
v_cvt_pk_bf16_f32 v106, v68, v69
v_cvt_pk_bf16_f32 v107, v70, v71
v_mfma_f32_16x16x32_bf16 v[40:43], v[92:95], v[22:25], 0
s_waitcnt lgkmcnt(0)
s_waitcnt vmcnt(17)
s_barrier
v_mov_b32 v116, -1
v_mov_b32 v117, -1
v_mov_b32 v118, -1
v_mov_b32 v119, -1
s_add_u32 s78, s69, 0x8000
buffer_store_dwordx4 v[116:119], v1, s[44:47], s78 offen sc1
buffer_store_dwordx4 v[116:119], v1, s[44:47], s78 offen offset:1024 sc1
s_add_u32 m0, s75, 0x8000
s_add_u32 s76, s66, 0
buffer_load_dwordx4 v109, s[24:27], s76 offen lds
v_mfma_f32_16x16x32_bf16 v[44:47], v[92:95], v[24:27], 0
v_mfma_f32_16x16x32_bf16 v[48:51], v[96:99], v[22:25], 0
v_mfma_f32_16x16x32_bf16 v[52:55], v[96:99], v[24:27], 0
s_add_u32 m0, s75, 0x8400
s_add_u32 s77, s66, 0xe000
buffer_load_dwordx4 v109, s[24:27], s77 offen lds
v_mfma_f32_16x16x32_bf16 v[56:59], v[100:103], v[22:25], 0
v_mfma_f32_16x16x32_bf16 v[60:63], v[100:103], v[24:27], 0
s_add_u32 m0, s75, 0x8800
s_add_u32 s76, s66, 0x1c000
buffer_load_dwordx4 v109, s[24:27], s76 offen lds
v_mfma_f32_16x16x32_bf16 v[64:67], v[104:107], v[22:25], 0
v_mfma_f32_16x16x32_bf16 v[68:71], v[104:107], v[24:27], 0
v_cvt_pk_bf16_f32 v72, v40, v41
s_add_u32 m0, s75, 0x8c00
s_add_u32 s77, s66, 0x2a000
buffer_load_dwordx4 v109, s[24:27], s77 offen lds
v_cvt_pk_bf16_f32 v73, v42, v43
v_cvt_pk_bf16_f32 v74, v48, v49
v_cvt_pk_bf16_f32 v75, v50, v51
v_cvt_pk_bf16_f32 v76, v44, v45
v_cvt_pk_bf16_f32 v77, v46, v47
v_cvt_pk_bf16_f32 v78, v52, v53
v_cvt_pk_bf16_f32 v79, v54, v55
s_add_u32 m0, s62, 0x2000
s_add_u32 s76, s14, 0
buffer_load_dwordx4 v2, s[28:31], s76 offen lds
v_cvt_pk_bf16_f32 v80, v56, v57
v_cvt_pk_bf16_f32 v81, v58, v59
v_cvt_pk_bf16_f32 v82, v64, v65
v_cvt_pk_bf16_f32 v83, v66, v67
v_cvt_pk_bf16_f32 v84, v60, v61
v_cvt_pk_bf16_f32 v85, v62, v63
v_cvt_pk_bf16_f32 v86, v68, v69
buffer_load_dwordx4 v3, s[28:31], s76 offen offset:1024 lds
v_cvt_pk_bf16_f32 v87, v70, v71
v_mfma_f32_16x16x32_bf16 v[40:43], v[72:75], v[32:35], 0
v_mfma_f32_16x16x32_bf16 v[56:59], v[72:75], v[28:31], 0
buffer_load_dwordx4 v4, s[28:31], s76 offen offset:2048 lds
v_mfma_f32_16x16x32_bf16 v[44:47], v[76:79], v[32:35], 0
v_mfma_f32_16x16x32_bf16 v[60:63], v[76:79], v[28:31], 0
v_mfma_f32_16x16x32_bf16 v[48:51], v[80:83], v[36:39], 0
buffer_load_dwordx4 v14, s[28:31], s76 offen offset:3072 lds
v_mfma_f32_16x16x32_bf16 v[64:67], v[80:83], v[28:31], 0
v_mfma_f32_16x16x32_bf16 v[52:55], v[84:87], v[36:39], 0
v_mfma_f32_16x16x32_bf16 v[68:71], v[84:87], v[28:31], 0
s_add_u32 s9, s62, 0x3000
v_add_u32 v8, s9, v1
s_lshl_b32 s9, s4, 8
s_add_u32 s9, s9, 0x13c00
v_and_b32 v9, 48, v0
v_add_u32 v9, s9, v9
ds_write_b128 v8, v[40:43]
ds_write_b128 v9, v[56:59]
ds_write_b128 v8, v[44:47] offset:1024
ds_write_b128 v9, v[60:63] offset:64
ds_write_b128 v8, v[48:51] offset:2048
ds_write_b128 v9, v[64:67] offset:128
ds_write_b128 v8, v[52:55] offset:3072
ds_write_b128 v9, v[68:71] offset:192
s_waitcnt lgkmcnt(0)
s_waitcnt vmcnt(23)
s_barrier
buffer_load_dword v12, v111, s[44:47], 0 offen sc1
s_lshl_b32 s9, s4, 10
s_add_u32 s9, s9, 0x3000
v_add_u32 v8, s9, v1
s_lshl_b32 s9, s4, 6
s_add_u32 s9, s9, 0x13c00
v_and_b32 v9, 48, v0
v_add_u32 v9, s9, v9
ds_read_b128 v[72:75], v8
ds_read_b128 v[88:91], v9
ds_read_b128 v[76:79], v8 offset:16384
ds_read_b128 v[92:95], v9 offset:256
ds_read_b128 v[80:83], v8 offset:32768
ds_read_b128 v[96:99], v9 offset:512
ds_read_b128 v[84:87], v8 offset:49152
ds_read_b128 v[100:103], v9 offset:768
v_and_b32 v10, 15, v0
v_cmp_eq_u32 vcc, 0, v10
v_and_b32 v11, 48, v0
v_mov_b32 v10, 0x7ffffff0
v_cndmask_b32 v10, v10, v11, vcc
s_lshl_b32 s9, s5, 10
s_add_u32 s9, s9, s73
s_sub_u32 s10, s9, 0x40000
s_lshr_b32 s10, s10, 3
s_add_u32 s10, s10, 0x20000
s_waitcnt lgkmcnt(5)
v_add_f32 v72, v72, v76
s_waitcnt lgkmcnt(1)
v_add_f32 v80, v80, v84
v_add_f32 v73, v73, v77
v_add_f32 v81, v81, v85
v_add_f32 v74, v74, v78
v_add_f32 v82, v82, v86
v_add_f32 v75, v75, v79
v_add_f32 v83, v83, v87
v_add_f32 v72, v72, v80
v_add_f32 v73, v73, v81
v_add_f32 v74, v74, v82
v_add_f32 v75, v75, v83
v_add_f32 v88, v88, v92
s_waitcnt lgkmcnt(0)
v_add_f32 v96, v96, v100
v_add_f32 v89, v89, v93
v_add_f32 v97, v97, v101
v_add_f32 v90, v90, v94
v_add_f32 v98, v98, v102
v_add_f32 v91, v91, v95
v_add_f32 v99, v99, v103
v_add_f32 v88, v88, v96
v_add_f32 v89, v89, v97
v_add_f32 v90, v90, v98
v_add_f32 v91, v91, v99
buffer_store_dwordx4 v[72:75], v1, s[44:47], s9 offen sc1
buffer_store_dwordx4 v[88:91], v10, s[44:47], s10 offen sc1
v_lshrrev_b32 v10, 1, v10
v_mov_b32 v76, -1
v_mov_b32 v77, -1
s_sub_u32 s9, s73, 0x40000
s_lshr_b32 s9, s9, 5
s_lshl_b32 s10, s5, 5
s_add_u32 s9, s9, s10
s_add_u32 s9, s9, 0x180000
buffer_store_dwordx2 v[76:77], v10, s[44:47], s9 offen sc1
ds_read_b64 v[32:33], v110
ds_read_b64 v[34:35], v110 offset:1024
ds_read_b64 v[36:37], v110 offset:256
ds_read_b64 v[38:39], v110 offset:1280
s_waitcnt lgkmcnt(2)
v_mfma_f32_16x16x32_bf16 v[40:43], v[16:19], v[32:35], 0
s_waitcnt lgkmcnt(0)
v_mfma_f32_16x16x32_bf16 v[44:47], v[16:19], v[36:39], 0
v_mfma_f32_16x16x32_bf16 v[48:51], v[18:21], v[32:35], 0
v_mfma_f32_16x16x32_bf16 v[52:55], v[18:21], v[36:39], 0
s_nop 3
v_max3_f32 v72, v40, v41, v42
v_min3_f32 v76, v40, v41, v42
v_max3_f32 v73, v44, v45, v46
v_min3_f32 v77, v44, v45, v46
v_max3_f32 v74, v48, v49, v50
v_min3_f32 v78, v48, v49, v50
v_max3_f32 v75, v52, v53, v54
v_min3_f32 v79, v52, v53, v54
v_max_f32 v72, v72, v43
v_min_f32 v76, v76, v43
v_max_f32 v73, v73, v47
v_min_f32 v77, v77, v47
v_max_f32 v74, v74, v51
v_min_f32 v78, v78, v51
v_max_f32 v75, v75, v55
v_min_f32 v79, v79, v55
v_permlane16_swap_b32 v72, v73
v_permlane16_swap_b32 v76, v77
v_permlane16_swap_b32 v74, v75
v_permlane16_swap_b32 v78, v79
v_max_f32 v72, v72, v73
v_min_f32 v76, v76, v77
v_max_f32 v74, v74, v75
v_min_f32 v78, v78, v79
s_nop 0
v_permlane32_swap_b32 v72, v74
v_permlane32_swap_b32 v76, v78
v_max_f32 v72, v72, v74
v_min_f32 v76, v76, v78
v_mov_b32 v74, v72
v_mov_b32 v78, v76
s_nop 0
v_permlane32_swap_b32 v72, v74
v_permlane32_swap_b32 v76, v78
v_mov_b32 v73, v72
v_mov_b32 v77, v76
v_mov_b32 v75, v74
v_mov_b32 v79, v78
v_permlane16_swap_b32 v72, v73
v_permlane16_swap_b32 v76, v77
v_permlane16_swap_b32 v74, v75
v_permlane16_swap_b32 v78, v79
v_mul_f32 v72, s56, v72
v_mul_f32 v76, s56, v76
v_mul_f32 v73, s56, v73
v_mul_f32 v77, s56, v77
s_waitcnt vmcnt(18)
s_barrier
s_waitcnt vmcnt(3)
v_cmp_gt_u32 vcc, 16, v12
s_nop 1
s_and_b32 vcc_lo, vcc_lo, 3
s_cbranch_scc0 L_pk_ok
s_mov_b32 s59, 0x40000
L_pk_spin:
buffer_load_dword v12, v111, s[44:47], 0 offen sc1
s_waitcnt vmcnt(0)
v_cmp_gt_u32 vcc, 16, v12
s_sub_u32 s59, s59, 1
s_cbranch_scc1 L_pk_ok
s_and_b32 vcc_lo, vcc_lo, 3
s_cbranch_scc1 L_pk_spin
L_pk_ok:
ds_read_b64_tr_b16 v[128:129], v112
ds_read_b64_tr_b16 v[130:131], v112 offset:256
ds_read_b64_tr_b16 v[132:133], v113
ds_read_b64_tr_b16 v[134:135], v113 offset:256
ds_read_b64_tr_b16 v[136:137], v114
ds_read_b64_tr_b16 v[138:139], v114 offset:256
ds_read_b64_tr_b16 v[140:141], v115
ds_read_b64_tr_b16 v[142:143], v115 offset:256
s_add_u32 m0, s75, 0xc000
s_add_u32 s77, s67, 0x28000
buffer_load_dwordx4 v1, s[44:47], s77 offen lds
v_mul_f32 v74, s56, v74
v_mul_f32 v78, s56, v78
v_mul_f32 v75, s56, v75
v_mul_f32 v79, s56, v79
v_fma_f32 v56, v40, s57, v76
buffer_load_dwordx4 v1, s[44:47], s77 offen offset:1024 lds
v_fma_f32 v40, v40, s56, -v72
v_fma_f32 v57, v41, s57, v76
v_fma_f32 v41, v41, s56, -v72
v_fma_f32 v58, v42, s57, v76
v_fma_f32 v42, v42, s56, -v72
buffer_load_dwordx4 v1, s[44:47], s77 offen offset:2048 lds
v_fma_f32 v59, v43, s57, v76
v_fma_f32 v43, v43, s56, -v72
v_exp_f32 v56, v56
v_exp_f32 v40, v40
buffer_load_dwordx4 v1, s[44:47], s77 offen offset:3072 lds
v_exp_f32 v57, v57
v_exp_f32 v41, v41
v_exp_f32 v58, v58
s_add_u32 m0, s75, 0x10000
s_add_u32 s76, s68, 0x28000
buffer_load_dwordx4 v1, s[44:47], s76 offen lds
v_exp_f32 v42, v42
v_exp_f32 v59, v59
v_exp_f32 v43, v43
buffer_load_dwordx4 v1, s[44:47], s76 offen offset:1024 lds
v_fma_f32 v60, v44, s57, v77
v_fma_f32 v44, v44, s56, -v73
v_fma_f32 v61, v45, s57, v77
v_fma_f32 v45, v45, s56, -v73
v_fma_f32 v62, v46, s57, v77
buffer_load_dwordx4 v1, s[44:47], s76 offen offset:2048 lds
v_fma_f32 v46, v46, s56, -v73
v_fma_f32 v63, v47, s57, v77
v_fma_f32 v47, v47, s56, -v73
v_exp_f32 v60, v60
v_exp_f32 v44, v44
buffer_load_dwordx4 v1, s[44:47], s76 offen offset:3072 lds
v_exp_f32 v61, v61
v_exp_f32 v45, v45
v_exp_f32 v62, v62
s_waitcnt lgkmcnt(0)
s_add_u32 m0, s62, 0
s_add_u32 s77, s15, 0
buffer_load_dwordx4 v2, s[28:31], s77 offen lds
v_exp_f32 v46, v46
v_exp_f32 v63, v63
v_exp_f32 v47, v47
buffer_load_dwordx4 v3, s[28:31], s77 offen offset:1024 lds
v_fma_f32 v64, v48, s57, v78
v_fma_f32 v48, v48, s56, -v74
v_fma_f32 v65, v49, s57, v78
v_fma_f32 v49, v49, s56, -v74
buffer_load_dwordx4 v4, s[28:31], s77 offen offset:2048 lds
v_fma_f32 v66, v50, s57, v78
v_fma_f32 v50, v50, s56, -v74
v_fma_f32 v67, v51, s57, v78
v_fma_f32 v51, v51, s56, -v74
v_exp_f32 v64, v64
buffer_load_dwordx4 v14, s[28:31], s77 offen offset:3072 lds
v_exp_f32 v48, v48
v_exp_f32 v65, v65
v_exp_f32 v49, v49
v_exp_f32 v66, v66
v_exp_f32 v50, v50
v_exp_f32 v67, v67
v_exp_f32 v51, v51
v_fma_f32 v68, v52, s57, v79
v_fma_f32 v52, v52, s56, -v75
v_fma_f32 v69, v53, s57, v79
v_fma_f32 v53, v53, s56, -v75
v_fma_f32 v70, v54, s57, v79
v_fma_f32 v54, v54, s56, -v75
v_fma_f32 v71, v55, s57, v79
v_fma_f32 v55, v55, s56, -v75
v_exp_f32 v68, v68
v_exp_f32 v52, v52
v_exp_f32 v69, v69
v_exp_f32 v53, v53
v_exp_f32 v70, v70
s_barrier
s_waitcnt vmcnt(12)
v_mov_b32 v13, 1
buffer_atomic_add v13, v6, s[44:47], s74 offen sc1
ds_read_b64_tr_b16 v[144:145], v112 offset:4096
ds_read_b64_tr_b16 v[146:147], v112 offset:4352
ds_read_b64_tr_b16 v[148:149], v113 offset:4096
ds_read_b64_tr_b16 v[150:151], v113 offset:4352
ds_read_b64_tr_b16 v[152:153], v114 offset:4096
ds_read_b64_tr_b16 v[154:155], v114 offset:4352
ds_read_b64_tr_b16 v[156:157], v115 offset:4096
ds_read_b64_tr_b16 v[158:159], v115 offset:4352
s_add_u32 m0, s75, 0
s_add_u32 s76, s67, 0x30000
buffer_load_dwordx4 v1, s[44:47], s76 offen lds
v_exp_f32 v54, v54
v_exp_f32 v71, v71
v_exp_f32 v55, v55
v_add_f32 v84, v40, v41
v_add_f32 v88, v56, v57
v_add_f32 v80, v42, v43
buffer_load_dwordx4 v1, s[44:47], s76 offen offset:1024 lds
v_add_f32 v81, v58, v59
v_add_f32 v84, v84, v80
v_add_f32 v88, v88, v81
v_add_f32 v85, v44, v45
v_add_f32 v89, v60, v61
v_add_f32 v80, v46, v47
v_add_f32 v81, v62, v63
buffer_load_dwordx4 v1, s[44:47], s76 offen offset:2048 lds
v_add_f32 v85, v85, v80
v_add_f32 v89, v89, v81
v_add_f32 v86, v48, v49
v_add_f32 v90, v64, v65
v_add_f32 v80, v50, v51
v_add_f32 v81, v66, v67
v_add_f32 v86, v86, v80
buffer_load_dwordx4 v1, s[44:47], s76 offen offset:3072 lds
v_add_f32 v90, v90, v81
v_add_f32 v87, v52, v53
v_add_f32 v91, v68, v69
v_add_f32 v80, v54, v55
v_add_f32 v81, v70, v71
v_add_f32 v87, v87, v80
v_add_f32 v91, v91, v81
s_waitcnt lgkmcnt(0)
s_add_u32 m0, s62, 0x1000
s_add_u32 s77, s12, 0x8000
buffer_load_dwordx4 v2, s[28:31], s77 offen lds
v_permlane16_swap_b32 v84, v85
v_permlane16_swap_b32 v88, v89
v_permlane16_swap_b32 v86, v87
v_permlane16_swap_b32 v90, v91
v_add_f32 v84, v84, v85
v_add_f32 v88, v88, v89
v_add_f32 v86, v86, v87
buffer_load_dwordx4 v3, s[28:31], s77 offen offset:1024 lds
v_add_f32 v90, v90, v91
v_permlane32_swap_b32 v84, v86
s_nop 0
v_permlane32_swap_b32 v88, v90
v_add_f32 v84, v84, v86
v_add_f32 v88, v88, v90
v_mov_b32 v86, v84
v_mov_b32 v90, v88
buffer_load_dwordx4 v4, s[28:31], s77 offen offset:2048 lds
v_permlane32_swap_b32 v84, v86
v_permlane32_swap_b32 v88, v90
v_mov_b32 v85, v84
v_mov_b32 v89, v88
v_mov_b32 v87, v86
v_mov_b32 v91, v90
v_permlane16_swap_b32 v84, v85
buffer_load_dwordx4 v14, s[28:31], s77 offen offset:3072 lds
v_permlane16_swap_b32 v88, v89
v_permlane16_swap_b32 v86, v87
v_permlane16_swap_b32 v90, v91
v_rcp_f32 v84, v84
v_rcp_f32 v88, v88
v_rcp_f32 v85, v85
v_rcp_f32 v89, v89
v_rcp_f32 v86, v86
v_rcp_f32 v90, v90
v_rcp_f32 v87, v87
v_rcp_f32 v91, v91
v_mul_f32 v40, v40, v84
v_mul_f32 v56, v56, v88
v_mul_f32 v41, v41, v84
v_mul_f32 v57, v57, v88
v_mul_f32 v42, v42, v84
v_mul_f32 v58, v58, v88
v_mul_f32 v43, v43, v84
v_mul_f32 v59, v59, v88
v_cvt_pk_bf16_f32 v92, v40, v41
v_cvt_pk_bf16_f32 v93, v42, v43
v_cvt_pk_bf16_f32 v94, v56, v57
v_cvt_pk_bf16_f32 v95, v58, v59
v_mul_f32 v44, v44, v85
v_mul_f32 v60, v60, v89
v_mul_f32 v45, v45, v85
v_mul_f32 v61, v61, v89
v_mul_f32 v46, v46, v85
v_mul_f32 v62, v62, v89
v_mul_f32 v47, v47, v85
v_mul_f32 v63, v63, v89
v_cvt_pk_bf16_f32 v96, v44, v45
v_cvt_pk_bf16_f32 v97, v46, v47
v_cvt_pk_bf16_f32 v98, v60, v61
v_cvt_pk_bf16_f32 v99, v62, v63
v_mul_f32 v48, v48, v86
v_mul_f32 v64, v64, v90
v_mul_f32 v49, v49, v86
v_mul_f32 v65, v65, v90
v_mul_f32 v50, v50, v86
v_mul_f32 v66, v66, v90
s_waitcnt vmcnt(17)
s_barrier
v_mov_b32 v13, 64
buffer_atomic_add v13, v6, s[44:47], s71 offen sc1
ds_read_b64_tr_b16 v[160:161], v112 offset:8192
ds_read_b64_tr_b16 v[162:163], v112 offset:8448
ds_read_b64_tr_b16 v[164:165], v113 offset:8192
ds_read_b64_tr_b16 v[166:167], v113 offset:8448
ds_read_b64_tr_b16 v[168:169], v114 offset:8192
ds_read_b64_tr_b16 v[170:171], v114 offset:8448
ds_read_b64_tr_b16 v[172:173], v115 offset:8192
ds_read_b64_tr_b16 v[174:175], v115 offset:8448
s_add_u32 m0, s75, 0x4000
s_add_u32 s76, s68, 0x30000
buffer_load_dwordx4 v1, s[44:47], s76 offen lds
v_mul_f32 v51, v51, v86
v_mul_f32 v67, v67, v90
v_cvt_pk_bf16_f32 v100, v48, v49
v_cvt_pk_bf16_f32 v101, v50, v51
v_cvt_pk_bf16_f32 v102, v64, v65
v_cvt_pk_bf16_f32 v103, v66, v67
v_mul_f32 v52, v52, v87
v_mul_f32 v68, v68, v91
buffer_load_dwordx4 v1, s[44:47], s76 offen offset:1024 lds
v_mul_f32 v53, v53, v87
v_mul_f32 v69, v69, v91
v_mul_f32 v54, v54, v87
v_mul_f32 v70, v70, v91
v_mul_f32 v55, v55, v87
v_mul_f32 v71, v71, v91
v_cvt_pk_bf16_f32 v104, v52, v53
buffer_load_dwordx4 v1, s[44:47], s76 offen offset:2048 lds
v_cvt_pk_bf16_f32 v105, v54, v55
v_cvt_pk_bf16_f32 v106, v68, v69
v_cvt_pk_bf16_f32 v107, v70, v71
buffer_load_dwordx4 v1, s[44:47], s76 offen offset:3072 lds
s_waitcnt lgkmcnt(0)
s_add_u32 m0, s62, 0x2000
s_add_u32 s77, s13, 0x8000
buffer_load_dwordx4 v2, s[28:31], s77 offen lds
buffer_load_dwordx4 v3, s[28:31], s77 offen offset:1024 lds
buffer_load_dwordx4 v4, s[28:31], s77 offen offset:2048 lds
buffer_load_dwordx4 v14, s[28:31], s77 offen offset:3072 lds
s_waitcnt vmcnt(22)
s_barrier
buffer_load_dword v12, v6, s[44:47], s74 offen sc1
s_add_u32 m0, s75, 0x8000
s_add_u32 s76, s67, 0x38000
buffer_load_dwordx4 v1, s[44:47], s76 offen lds
buffer_load_dwordx4 v1, s[44:47], s76 offen offset:1024 lds
buffer_load_dwordx4 v1, s[44:47], s76 offen offset:2048 lds
buffer_load_dwordx4 v1, s[44:47], s76 offen offset:3072 lds
s_add_u32 m0, s62, 0x3000
s_add_u32 s77, s14, 0x8000
buffer_load_dwordx4 v2, s[28:31], s77 offen lds
buffer_load_dwordx4 v3, s[28:31], s77 offen offset:1024 lds
buffer_load_dwordx4 v4, s[28:31], s77 offen offset:2048 lds
buffer_load_dwordx4 v14, s[28:31], s77 offen offset:3072 lds
s_waitcnt vmcnt(22)
s_barrier
s_waitcnt vmcnt(8)
v_readfirstlane_b32 s58, v12
s_nop 1
s_cmp_ge_u32 s58, 16
s_cbranch_scc1 L_kv_ok
s_mov_b32 s59, 0x40000
L_kv_spin:
buffer_load_dword v12, v6, s[44:47], s74 offen sc1
s_waitcnt vmcnt(0)
v_readfirstlane_b32 s58, v12
s_sub_u32 s59, s59, 1
s_cmp_eq_u32 s59, 0
s_cbranch_scc1 L_kv_ok
s_cmp_ge_u32 s58, 16
s_cbranch_scc0 L_kv_spin
L_kv_ok:
v_and_b32 v10, 15, v0
v_lshlrev_b32 v9, 10, v10
v_lshlrev_b32 v10, 7, v10
v_and_b32 v11, 48, v0
v_add_u32 v10, v10, v11
v_add_u32 v9, v9, v11
s_lshl_b32 s9, s5, 6
s_add_u32 s9, s9, s73
buffer_load_dwordx4 v[16:19], v9, s[44:47], s9 offen sc1
s_sub_u32 s9, s73, 0x40000
s_lshr_b32 s9, s9, 3
s_add_u32 s9, s9, 0x20000
buffer_load_dwordx4 v[80:83], v10, s[44:47], s9 offen sc1
ds_read_b64_tr_b16 v[176:177], v112
ds_read_b64_tr_b16 v[178:179], v112 offset:256
ds_read_b64_tr_b16 v[180:181], v113
ds_read_b64_tr_b16 v[182:183], v113 offset:256
ds_read_b64_tr_b16 v[184:185], v114
ds_read_b64_tr_b16 v[186:187], v114 offset:256
ds_read_b64_tr_b16 v[188:189], v115
ds_read_b64_tr_b16 v[190:191], v115 offset:256
s_add_u32 m0, s75, 0xc000
s_add_u32 s76, s68, 0x38000
buffer_load_dwordx4 v1, s[44:47], s76 offen lds
buffer_load_dwordx4 v1, s[44:47], s76 offen offset:1024 lds
buffer_load_dwordx4 v1, s[44:47], s76 offen offset:2048 lds
buffer_load_dwordx4 v1, s[44:47], s76 offen offset:3072 lds
s_waitcnt lgkmcnt(0)
s_add_u32 m0, s62, 0
s_add_u32 s77, s15, 0x8000
buffer_load_dwordx4 v2, s[28:31], s77 offen lds
buffer_load_dwordx4 v3, s[28:31], s77 offen offset:1024 lds
buffer_load_dwordx4 v4, s[28:31], s77 offen offset:2048 lds
buffer_load_dwordx4 v14, s[28:31], s77 offen offset:3072 lds
s_barrier
v_and_b32 v10, 15, v0
v_cmp_eq_u32 vcc, 0, v10
v_bfe_u32 v11, v0, 4, 2
v_lshlrev_b32 v11, 3, v11
v_mov_b32 v10, 0x3ffffff8
v_cndmask_b32 v10, v10, v11, vcc
s_sub_u32 s9, s73, 0x40000
s_lshr_b32 s9, s9, 5
s_lshl_b32 s10, s5, 5
s_add_u32 s9, s9, s10
s_add_u32 s9, s9, 0x180000
s_waitcnt vmcnt(9)
v_add_f32_dpp v16, v16, v16 row_ror:8 row_mask:0xf bank_mask:0xf
v_add_f32_dpp v17, v17, v17 row_ror:8 row_mask:0xf bank_mask:0xf
v_add_f32_dpp v18, v18, v18 row_ror:8 row_mask:0xf bank_mask:0xf
v_add_f32_dpp v19, v19, v19 row_ror:8 row_mask:0xf bank_mask:0xf
v_add_f32_dpp v16, v16, v16 row_ror:4 row_mask:0xf bank_mask:0xf
v_add_f32_dpp v17, v17, v17 row_ror:4 row_mask:0xf bank_mask:0xf
v_add_f32_dpp v18, v18, v18 row_ror:4 row_mask:0xf bank_mask:0xf
v_add_f32_dpp v19, v19, v19 row_ror:4 row_mask:0xf bank_mask:0xf
v_add_f32_dpp v16, v16, v16 row_ror:2 row_mask:0xf bank_mask:0xf
v_add_f32_dpp v17, v17, v17 row_ror:2 row_mask:0xf bank_mask:0xf
v_add_f32_dpp v18, v18, v18 row_ror:2 row_mask:0xf bank_mask:0xf
v_add_f32_dpp v19, v19, v19 row_ror:2 row_mask:0xf bank_mask:0xf
v_add_f32_dpp v16, v16, v16 row_ror:1 row_mask:0xf bank_mask:0xf
v_add_f32_dpp v17, v17, v17 row_ror:1 row_mask:0xf bank_mask:0xf
v_add_f32_dpp v18, v18, v18 row_ror:1 row_mask:0xf bank_mask:0xf
v_add_f32_dpp v19, v19, v19 row_ror:1 row_mask:0xf bank_mask:0xf
v_cvt_pk_bf16_f32 v16, v16, v17
v_cvt_pk_bf16_f32 v17, v18, v19
buffer_store_dwordx2 v[16:17], v10, s[44:47], s9 offen sc1
s_waitcnt vmcnt(9)
v_add_f32_dpp v80, v80, v80 row_ror:8 row_mask:0xf bank_mask:0xf
v_add_f32_dpp v81, v81, v81 row_ror:8 row_mask:0xf bank_mask:0xf
v_add_f32_dpp v82, v82, v82 row_ror:8 row_mask:0xf bank_mask:0xf
v_add_f32_dpp v83, v83, v83 row_ror:8 row_mask:0xf bank_mask:0xf
v_add_f32_dpp v80, v80, v80 row_ror:4 row_mask:0xf bank_mask:0xf
v_add_f32_dpp v81, v81, v81 row_ror:4 row_mask:0xf bank_mask:0xf
v_add_f32_dpp v82, v82, v82 row_ror:4 row_mask:0xf bank_mask:0xf
v_add_f32_dpp v83, v83, v83 row_ror:4 row_mask:0xf bank_mask:0xf
v_add_f32_dpp v80, v80, v80 row_ror:2 row_mask:0xf bank_mask:0xf
v_add_f32_dpp v81, v81, v81 row_ror:2 row_mask:0xf bank_mask:0xf
v_add_f32_dpp v82, v82, v82 row_ror:2 row_mask:0xf bank_mask:0xf
v_add_f32_dpp v83, v83, v83 row_ror:2 row_mask:0xf bank_mask:0xf
v_add_f32_dpp v80, v80, v80 row_ror:1 row_mask:0xf bank_mask:0xf
v_add_f32_dpp v81, v81, v81 row_ror:1 row_mask:0xf bank_mask:0xf
v_add_f32_dpp v82, v82, v82 row_ror:1 row_mask:0xf bank_mask:0xf
v_add_f32_dpp v83, v83, v83 row_ror:1 row_mask:0xf bank_mask:0xf
v_cvt_pk_bf16_f32 v80, v80, v81
v_cvt_pk_bf16_f32 v81, v82, v83
ds_read_b64_tr_b16 v[192:193], v112 offset:4096
ds_read_b64_tr_b16 v[194:195], v112 offset:4352
ds_read_b64_tr_b16 v[196:197], v113 offset:4096
ds_read_b64_tr_b16 v[198:199], v113 offset:4352
ds_read_b64_tr_b16 v[200:201], v114 offset:4096
ds_read_b64_tr_b16 v[202:203], v114 offset:4352
ds_read_b64_tr_b16 v[204:205], v115 offset:4096
ds_read_b64_tr_b16 v[206:207], v115 offset:4352
s_add_u32 m0, s75, 0x10000
s_add_u32 s76, s67, 0x40000
buffer_load_dwordx4 v1, s[44:47], s76 offen lds
buffer_load_dwordx4 v1, s[44:47], s76 offen offset:1024 lds
buffer_load_dwordx4 v1, s[44:47], s76 offen offset:2048 lds
buffer_load_dwordx4 v1, s[44:47], s76 offen offset:3072 lds
s_waitcnt lgkmcnt(0)
s_add_u32 m0, s62, 0x1000
s_add_u32 s77, s36, 0
buffer_load_dwordx4 v2, s[32:35], s77 offen lds
buffer_load_dwordx4 v3, s[32:35], s77 offen offset:1024 lds
buffer_load_dwordx4 v4, s[32:35], s77 offen offset:2048 lds
buffer_load_dwordx4 v14, s[32:35], s77 offen offset:3072 lds
s_barrier
ds_read_b64_tr_b16 v[208:209], v112 offset:8192
ds_read_b64_tr_b16 v[210:211], v112 offset:8448
ds_read_b64_tr_b16 v[212:213], v113 offset:8192
ds_read_b64_tr_b16 v[214:215], v113 offset:8448
ds_read_b64_tr_b16 v[216:217], v114 offset:8192
ds_read_b64_tr_b16 v[218:219], v114 offset:8448
ds_read_b64_tr_b16 v[220:221], v115 offset:8192
ds_read_b64_tr_b16 v[222:223], v115 offset:8448
s_add_u32 m0, s75, 0
s_add_u32 s76, s68, 0x40000
buffer_load_dwordx4 v1, s[44:47], s76 offen lds
buffer_load_dwordx4 v1, s[44:47], s76 offen offset:1024 lds
buffer_load_dwordx4 v1, s[44:47], s76 offen offset:2048 lds
buffer_load_dwordx4 v1, s[44:47], s76 offen offset:3072 lds
s_waitcnt lgkmcnt(0)
s_add_u32 m0, s62, 0x2000
s_add_u32 s77, s37, 0
buffer_load_dwordx4 v2, s[32:35], s77 offen lds
buffer_load_dwordx4 v3, s[32:35], s77 offen offset:1024 lds
buffer_load_dwordx4 v4, s[32:35], s77 offen offset:2048 lds
buffer_load_dwordx4 v14, s[32:35], s77 offen offset:3072 lds
s_waitcnt vmcnt(21)
s_barrier
v_lshlrev_b32 v9, 3, v0
s_sub_u32 s78, s73, 0x40000
s_lshr_b32 s78, s78, 5
s_add_u32 s78, s78, 0x180000
buffer_load_dwordx2 v[20:21], v9, s[44:47], s78 offen sc1
ds_read_b64_tr_b16 v[224:225], v112 offset:12288
ds_read_b64_tr_b16 v[226:227], v112 offset:12544
ds_read_b64_tr_b16 v[228:229], v113 offset:12288
ds_read_b64_tr_b16 v[230:231], v113 offset:12544
ds_read_b64_tr_b16 v[232:233], v114 offset:12288
ds_read_b64_tr_b16 v[234:235], v114 offset:12544
ds_read_b64_tr_b16 v[236:237], v115 offset:12288
ds_read_b64_tr_b16 v[238:239], v115 offset:12544
s_add_u32 m0, s75, 0x4000
s_add_u32 s76, s67, 0x48000
buffer_load_dwordx4 v1, s[44:47], s76 offen lds
buffer_load_dwordx4 v1, s[44:47], s76 offen offset:1024 lds
buffer_load_dwordx4 v1, s[44:47], s76 offen offset:2048 lds
buffer_load_dwordx4 v1, s[44:47], s76 offen offset:3072 lds
s_waitcnt lgkmcnt(0)
s_add_u32 m0, s62, 0x3000
s_add_u32 s77, s38, 0
buffer_load_dwordx4 v2, s[32:35], s77 offen lds
buffer_load_dwordx4 v3, s[32:35], s77 offen offset:1024 lds
buffer_load_dwordx4 v4, s[32:35], s77 offen offset:2048 lds
buffer_load_dwordx4 v14, s[32:35], s77 offen offset:3072 lds
s_waitcnt vmcnt(21)
s_barrier
ds_read_b64_tr_b16 v[240:241], v112
ds_read_b64_tr_b16 v[242:243], v112 offset:256
ds_read_b64_tr_b16 v[244:245], v113
ds_read_b64_tr_b16 v[246:247], v113 offset:256
ds_read_b64_tr_b16 v[248:249], v114
ds_read_b64_tr_b16 v[250:251], v114 offset:256
ds_read_b64_tr_b16 v[252:253], v115
ds_read_b64_tr_b16 v[254:255], v115 offset:256
s_add_u32 m0, s75, 0x8000
s_add_u32 s76, s68, 0x48000
buffer_load_dwordx4 v1, s[44:47], s76 offen lds
v_lshlrev_b32 v9, 3, v0
s_sub_u32 s78, s73, 0x40000
s_lshr_b32 s78, s78, 5
s_add_u32 s78, s78, 0x180000
s_waitcnt vmcnt(9)
v_max_u32 v13, v20, v21
v_cmp_eq_u32 vcc, -1, v13
s_nop 0
s_cbranch_vccz L_kv2_ok
s_mov_b32 s59, 0x10000
L_kv2_spin:
buffer_load_dwordx2 v[20:21], v9, s[44:47], s78 offen sc1
s_waitcnt vmcnt(0)
v_max_u32 v13, v20, v21
v_cmp_eq_u32 vcc, -1, v13
s_sub_u32 s59, s59, 1
s_cbranch_scc1 L_kv2_ok
s_cbranch_vccnz L_kv2_spin
L_kv2_ok:
buffer_load_dwordx4 v1, s[44:47], s76 offen offset:1024 lds
s_lshr_b32 s9, s4, 1
s_lshl_b32 s9, s9, 10
buffer_load_dwordx4 v1, s[44:47], s76 offen offset:2048 lds
s_and_b32 s10, s4, 1
s_lshl_b32 s10, s10, 3
s_add_u32 s9, s9, s10
s_add_u32 s9, s9, 0x12000
v_add_u32 v8, s9, v1
ds_write_b64 v8, v[20:21]
ds_write_b64 v8, v[80:81] offset:2048
buffer_load_dwordx4 v1, s[44:47], s76 offen offset:3072 lds
s_waitcnt lgkmcnt(0)
s_add_u32 m0, s62, 0
s_add_u32 s77, s39, 0
buffer_load_dwordx4 v2, s[32:35], s77 offen lds
buffer_load_dwordx4 v3, s[32:35], s77 offen offset:1024 lds
buffer_load_dwordx4 v4, s[32:35], s77 offen offset:2048 lds
buffer_load_dwordx4 v14, s[32:35], s77 offen offset:3072 lds
s_barrier
s_add_u32 m0, s75, 0xc000
s_add_u32 s76, s12, 0x10000
buffer_load_dwordx4 v2, s[28:31], s76 offen lds
v_add_u32 v8, 0x12000, v1
v_and_b32 v9, 15, v0
v_lshlrev_b32 v9, 2, v9
s_lshl_b32 s9, s4, 7
s_add_u32 s9, s9, 0x13800
v_add_u32 v9, s9, v9
ds_read_b128 v[24:27], v8 offset:2048
ds_read_b128 v[16:19], v8
ds_read_b128 v[28:31], v8 offset:3072
ds_read_b128 v[20:23], v8 offset:1024
ds_read_b32 v64, v9
ds_read_b32 v65, v9 offset:64
s_waitcnt lgkmcnt(5)
v_mfma_f32_16x16x32_bf16 v[48:51], v[24:27], v[92:95], 0
buffer_load_dwordx4 v3, s[28:31], s76 offen offset:1024 lds
v_mfma_f32_16x16x32_bf16 v[52:55], v[24:27], v[96:99], 0
s_waitcnt lgkmcnt(3)
v_mfma_f32_16x16x32_bf16 v[56:59], v[28:31], v[100:103], 0
v_mfma_f32_16x16x32_bf16 v[60:63], v[28:31], v[104:107], 0
v_mfma_f32_16x16x32_bf16 v[32:35], v[16:19], v[92:95], 0
buffer_load_dwordx4 v4, s[28:31], s76 offen offset:2048 lds
v_mfma_f32_16x16x32_bf16 v[36:39], v[16:19], v[96:99], 0
s_waitcnt lgkmcnt(2)
v_mfma_f32_16x16x32_bf16 v[40:43], v[20:23], v[100:103], 0
v_mfma_f32_16x16x32_bf16 v[44:47], v[20:23], v[104:107], 0
s_mov_b32 s9, 0x358637bd
v_add_f32 v48, s9, v48
v_add_f32 v52, s9, v52
v_add_f32 v56, s9, v56
buffer_load_dwordx4 v14, s[28:31], s76 offen offset:3072 lds
v_add_f32 v60, s9, v60
v_rcp_f32 v48, v48
v_rcp_f32 v52, v52
v_rcp_f32 v56, v56
v_rcp_f32 v60, v60
s_waitcnt lgkmcnt(1)
v_mul_f32 v48, v48, v64
s_waitcnt lgkmcnt(0)
v_mul_f32 v52, v52, v65
v_mul_f32 v56, v56, v64
v_mul_f32 v60, v60, v65
v_mul_f32 v32, v32, v48
v_mul_f32 v33, v33, v48
v_mul_f32 v34, v34, v48
v_mul_f32 v35, v35, v48
v_mul_f32 v36, v36, v52
v_mul_f32 v37, v37, v52
v_mul_f32 v38, v38, v52
v_mul_f32 v39, v39, v52
v_mul_f32 v40, v40, v56
v_mul_f32 v41, v41, v56
v_mul_f32 v42, v42, v56
v_mul_f32 v43, v43, v56
v_mul_f32 v44, v44, v60
v_mul_f32 v45, v45, v60
v_mul_f32 v46, v46, v60
v_mul_f32 v47, v47, v60
s_add_u32 s10, s69, 0x8000
v_cvt_pk_bf16_f32 v68, v32, v33
v_cvt_pk_bf16_f32 v69, v34, v35
v_cvt_pk_bf16_f32 v70, v40, v41
v_cvt_pk_bf16_f32 v71, v42, v43
buffer_store_dwordx4 v[68:71], v1, s[44:47], s10 offen sc1
v_cvt_pk_bf16_f32 v72, v36, v37
v_cvt_pk_bf16_f32 v73, v38, v39
v_cvt_pk_bf16_f32 v74, v44, v45
v_cvt_pk_bf16_f32 v75, v46, v47
buffer_store_dwordx4 v[72:75], v1, s[44:47], s10 offen offset:1024 sc1
s_waitcnt vmcnt(18)
s_barrier
buffer_load_dword v12, v6, s[44:47], s72 offen sc1
s_add_u32 m0, s75, 0x10000
s_add_u32 s77, s13, 0x10000
buffer_load_dwordx4 v2, s[28:31], s77 offen lds
buffer_load_dwordx4 v3, s[28:31], s77 offen offset:1024 lds
buffer_load_dwordx4 v4, s[28:31], s77 offen offset:2048 lds
buffer_load_dwordx4 v14, s[28:31], s77 offen offset:3072 lds
s_waitcnt vmcnt(15)
s_barrier
s_add_u32 m0, s75, 0
s_add_u32 s76, s14, 0x10000
buffer_load_dwordx4 v2, s[28:31], s76 offen lds
buffer_load_dwordx4 v3, s[28:31], s76 offen offset:1024 lds
buffer_load_dwordx4 v4, s[28:31], s76 offen offset:2048 lds
buffer_load_dwordx4 v14, s[28:31], s76 offen offset:3072 lds
s_waitcnt vmcnt(8)
v_readfirstlane_b32 s58, v12
s_nop 1
s_and_b32 s9, s58, 0x208
s_cmp_eq_u32 s9, 0x208
s_cbranch_scc1 L_pz_ok
s_mov_b32 s59, 0x40000
L_pz_spin:
buffer_load_dword v12, v6, s[44:47], s72 offen sc1
s_waitcnt vmcnt(0)
v_readfirstlane_b32 s58, v12
s_sub_u32 s59, s59, 1
s_cmp_eq_u32 s59, 0
s_cbranch_scc1 L_pz_ok
s_and_b32 s9, s58, 0x208
s_cmp_eq_u32 s9, 0x208
s_cbranch_scc0 L_pz_spin
L_pz_ok:
s_add_u32 s9, s4, 0
s_and_b32 s9, s9, 3
s_lshl_b32 s63, s9, 10
s_add_u32 s9, s4, 1
s_and_b32 s9, s9, 3
s_lshl_b32 s64, s9, 10
s_add_u32 s9, s4, 2
s_and_b32 s9, s9, 3
s_lshl_b32 s65, s9, 10
s_add_u32 s9, s4, 3
s_and_b32 s9, s9, 3
s_lshl_b32 s66, s9, 10
s_add_u32 s77, s40, 0
s_add_u32 s9, s77, s63
buffer_load_dwordx4 v[16:19], v1, s[44:47], s9 offen sc1
s_add_u32 s9, s77, s64
buffer_load_dwordx4 v[20:23], v1, s[44:47], s9 offen sc1
s_add_u32 s9, s77, s65
buffer_load_dwordx4 v[24:27], v1, s[44:47], s9 offen sc1
s_add_u32 s9, s77, s66
buffer_load_dwordx4 v[28:31], v1, s[44:47], s9 offen sc1
s_add_u32 s76, s41, 0
s_add_u32 s9, s76, s63
buffer_load_dwordx4 v[32:35], v1, s[44:47], s9 offen sc1
s_add_u32 s9, s76, s64
buffer_load_dwordx4 v[36:39], v1, s[44:47], s9 offen sc1
s_add_u32 s9, s76, s65
buffer_load_dwordx4 v[40:43], v1, s[44:47], s9 offen sc1
s_add_u32 s9, s76, s66
buffer_load_dwordx4 v[44:47], v1, s[44:47], s9 offen sc1
s_add_u32 s77, s42, 0
s_add_u32 s9, s77, s63
buffer_load_dwordx4 v[48:51], v1, s[44:47], s9 offen sc1
s_add_u32 s9, s77, s64
buffer_load_dwordx4 v[52:55], v1, s[44:47], s9 offen sc1
s_add_u32 s9, s77, s65
buffer_load_dwordx4 v[56:59], v1, s[44:47], s9 offen sc1
s_add_u32 s9, s77, s66
buffer_load_dwordx4 v[60:63], v1, s[44:47], s9 offen sc1
s_barrier
s_waitcnt vmcnt(11)
v_mfma_f32_16x16x32_bf16 v[64:67], v[128:131], v[16:19], 0
s_add_u32 m0, s75, 0x4000
v_mfma_f32_16x16x32_bf16 v[80:83], v[132:135], v[16:19], 0
s_add_u32 s76, s15, 0x10000
v_mfma_f32_16x16x32_bf16 v[96:99], v[136:139], v[16:19], 0
buffer_load_dwordx4 v2, s[28:31], s76 offen lds
v_mfma_f32_16x16x32_bf16 v[112:115], v[140:143], v[16:19], 0
buffer_load_dwordx4 v3, s[28:31], s76 offen offset:1024 lds
s_waitcnt vmcnt(12)
v_mfma_f32_16x16x32_bf16 v[68:71], v[128:131], v[20:23], 0
buffer_load_dwordx4 v4, s[28:31], s76 offen offset:2048 lds
v_mfma_f32_16x16x32_bf16 v[84:87], v[132:135], v[20:23], 0
buffer_load_dwordx4 v14, s[28:31], s76 offen offset:3072 lds
v_mfma_f32_16x16x32_bf16 v[100:103], v[136:139], v[20:23], 0
v_mfma_f32_16x16x32_bf16 v[116:119], v[140:143], v[20:23], 0
s_waitcnt vmcnt(13)
v_mfma_f32_16x16x32_bf16 v[72:75], v[128:131], v[24:27], 0
v_mfma_f32_16x16x32_bf16 v[88:91], v[132:135], v[24:27], 0
v_mfma_f32_16x16x32_bf16 v[104:107], v[136:139], v[24:27], 0
v_mfma_f32_16x16x32_bf16 v[120:123], v[140:143], v[24:27], 0
s_waitcnt vmcnt(12)
v_mfma_f32_16x16x32_bf16 v[76:79], v[128:131], v[28:31], 0
v_mfma_f32_16x16x32_bf16 v[92:95], v[132:135], v[28:31], 0
v_mfma_f32_16x16x32_bf16 v[108:111], v[136:139], v[28:31], 0
v_mfma_f32_16x16x32_bf16 v[124:127], v[140:143], v[28:31], 0
s_barrier
s_waitcnt vmcnt(11)
v_mfma_f32_16x16x32_bf16 v[64:67], v[144:147], v[32:35], v[64:67]
s_add_u32 m0, s75, 0x8000
s_add_u32 s77, s82, 0
v_mfma_f32_16x16x32_bf16 v[80:83], v[148:151], v[32:35], v[80:83]
buffer_load_dwordx4 v2, s[28:31], s77 offen lds
buffer_load_dwordx4 v3, s[28:31], s77 offen offset:1024 lds
v_mfma_f32_16x16x32_bf16 v[96:99], v[152:155], v[32:35], v[96:99]
buffer_load_dwordx4 v4, s[28:31], s77 offen offset:2048 lds
buffer_load_dwordx4 v14, s[28:31], s77 offen offset:3072 lds
v_mfma_f32_16x16x32_bf16 v[112:115], v[156:159], v[32:35], v[112:115]
s_add_u32 s76, s43, 0
s_add_u32 s9, s76, s63
s_waitcnt vmcnt(14)
v_mfma_f32_16x16x32_bf16 v[68:71], v[144:147], v[36:39], v[68:71]
buffer_load_dwordx4 v[16:19], v1, s[44:47], s9 offen sc1
s_add_u32 s9, s76, s64
v_mfma_f32_16x16x32_bf16 v[84:87], v[148:151], v[36:39], v[84:87]
buffer_load_dwordx4 v[20:23], v1, s[44:47], s9 offen sc1
s_add_u32 s9, s76, s65
v_mfma_f32_16x16x32_bf16 v[100:103], v[152:155], v[36:39], v[100:103]
buffer_load_dwordx4 v[24:27], v1, s[44:47], s9 offen sc1
s_add_u32 s9, s76, s66
v_mfma_f32_16x16x32_bf16 v[116:119], v[156:159], v[36:39], v[116:119]
buffer_load_dwordx4 v[28:31], v1, s[44:47], s9 offen sc1
s_add_u32 s77, s40, 0x4000
s_waitcnt vmcnt(17)
v_mfma_f32_16x16x32_bf16 v[72:75], v[144:147], v[40:43], v[72:75]
s_add_u32 s9, s77, s63
buffer_load_dwordx4 v[128:131], v1, s[44:47], s9 offen sc1
v_mfma_f32_16x16x32_bf16 v[88:91], v[148:151], v[40:43], v[88:91]
s_add_u32 s9, s77, s64
buffer_load_dwordx4 v[132:135], v1, s[44:47], s9 offen sc1
v_mfma_f32_16x16x32_bf16 v[104:107], v[152:155], v[40:43], v[104:107]
s_add_u32 s9, s77, s65
buffer_load_dwordx4 v[136:139], v1, s[44:47], s9 offen sc1
v_mfma_f32_16x16x32_bf16 v[120:123], v[156:159], v[40:43], v[120:123]
s_add_u32 s9, s77, s66
buffer_load_dwordx4 v[140:143], v1, s[44:47], s9 offen sc1
s_waitcnt vmcnt(20)
v_mfma_f32_16x16x32_bf16 v[76:79], v[144:147], v[44:47], v[76:79]
v_mfma_f32_16x16x32_bf16 v[92:95], v[148:151], v[44:47], v[92:95]
v_mfma_f32_16x16x32_bf16 v[108:111], v[152:155], v[44:47], v[108:111]
v_mfma_f32_16x16x32_bf16 v[124:127], v[156:159], v[44:47], v[124:127]
s_waitcnt vmcnt(19)
v_mfma_f32_16x16x32_bf16 v[64:67], v[160:163], v[48:51], v[64:67]
s_add_u32 s76, s41, 0x4000
s_add_u32 s9, s76, s63
v_mfma_f32_16x16x32_bf16 v[80:83], v[164:167], v[48:51], v[80:83]
buffer_load_dwordx4 v[32:35], v1, s[44:47], s9 offen sc1
s_add_u32 s9, s76, s64
v_mfma_f32_16x16x32_bf16 v[96:99], v[168:171], v[48:51], v[96:99]
buffer_load_dwordx4 v[36:39], v1, s[44:47], s9 offen sc1
s_add_u32 s9, s76, s65
v_mfma_f32_16x16x32_bf16 v[112:115], v[172:175], v[48:51], v[112:115]
buffer_load_dwordx4 v[40:43], v1, s[44:47], s9 offen sc1
s_add_u32 s9, s76, s66
s_waitcnt vmcnt(21)
v_mfma_f32_16x16x32_bf16 v[68:71], v[160:163], v[52:55], v[68:71]
buffer_load_dwordx4 v[44:47], v1, s[44:47], s9 offen sc1
s_add_u32 s77, s42, 0x4000
v_mfma_f32_16x16x32_bf16 v[84:87], v[164:167], v[52:55], v[84:87]
s_add_u32 s9, s77, s63
buffer_load_dwordx4 v[144:147], v1, s[44:47], s9 offen sc1
v_mfma_f32_16x16x32_bf16 v[100:103], v[168:171], v[52:55], v[100:103]
s_add_u32 s9, s77, s64
buffer_load_dwordx4 v[148:151], v1, s[44:47], s9 offen sc1
v_mfma_f32_16x16x32_bf16 v[116:119], v[172:175], v[52:55], v[116:119]
s_add_u32 s9, s77, s65
buffer_load_dwordx4 v[152:155], v1, s[44:47], s9 offen sc1
s_waitcnt vmcnt(24)
v_mfma_f32_16x16x32_bf16 v[72:75], v[160:163], v[56:59], v[72:75]
s_add_u32 s9, s77, s66
buffer_load_dwordx4 v[156:159], v1, s[44:47], s9 offen sc1
v_mfma_f32_16x16x32_bf16 v[88:91], v[164:167], v[56:59], v[88:91]
v_mfma_f32_16x16x32_bf16 v[104:107], v[168:171], v[56:59], v[104:107]
v_mfma_f32_16x16x32_bf16 v[120:123], v[172:175], v[56:59], v[120:123]
s_waitcnt vmcnt(24)
v_mfma_f32_16x16x32_bf16 v[76:79], v[160:163], v[60:63], v[76:79]
v_mfma_f32_16x16x32_bf16 v[92:95], v[164:167], v[60:63], v[92:95]
v_mfma_f32_16x16x32_bf16 v[108:111], v[168:171], v[60:63], v[108:111]
v_mfma_f32_16x16x32_bf16 v[124:127], v[172:175], v[60:63], v[124:127]
s_waitcnt vmcnt(15)
v_mfma_f32_16x16x32_bf16 v[64:67], v[176:179], v[16:19], v[64:67]
s_add_u32 s76, s43, 0x4000
s_add_u32 s9, s76, s63
v_mfma_f32_16x16x32_bf16 v[80:83], v[180:183], v[16:19], v[80:83]
buffer_load_dwordx4 v[48:51], v1, s[44:47], s9 offen sc1
s_add_u32 s9, s76, s64
v_mfma_f32_16x16x32_bf16 v[96:99], v[184:187], v[16:19], v[96:99]
buffer_load_dwordx4 v[52:55], v1, s[44:47], s9 offen sc1
s_add_u32 s9, s76, s65
v_mfma_f32_16x16x32_bf16 v[112:115], v[188:191], v[16:19], v[112:115]
buffer_load_dwordx4 v[56:59], v1, s[44:47], s9 offen sc1
s_add_u32 s9, s76, s66
s_waitcnt vmcnt(17)
v_mfma_f32_16x16x32_bf16 v[68:71], v[176:179], v[20:23], v[68:71]
buffer_load_dwordx4 v[60:63], v1, s[44:47], s9 offen sc1
s_add_u32 s77, s40, 0x8000
v_mfma_f32_16x16x32_bf16 v[84:87], v[180:183], v[20:23], v[84:87]
s_add_u32 s9, s77, s63
buffer_load_dwordx4 v[160:163], v1, s[44:47], s9 offen sc1
v_mfma_f32_16x16x32_bf16 v[100:103], v[184:187], v[20:23], v[100:103]
s_add_u32 s9, s77, s64
buffer_load_dwordx4 v[164:167], v1, s[44:47], s9 offen sc1
v_mfma_f32_16x16x32_bf16 v[116:119], v[188:191], v[20:23], v[116:119]
s_add_u32 s9, s77, s65
buffer_load_dwordx4 v[168:171], v1, s[44:47], s9 offen sc1
s_waitcnt vmcnt(20)
v_mfma_f32_16x16x32_bf16 v[72:75], v[176:179], v[24:27], v[72:75]
s_add_u32 s9, s77, s66
buffer_load_dwordx4 v[172:175], v1, s[44:47], s9 offen sc1
v_mfma_f32_16x16x32_bf16 v[88:91], v[180:183], v[24:27], v[88:91]
s_waitcnt vmcnt(19)
v_max3_u32 v13, v128, v129, v130
s_waitcnt vmcnt(18)
v_max3_u32 v13, v13, v131, v132
v_mfma_f32_16x16x32_bf16 v[104:107], v[184:187], v[24:27], v[104:107]
v_max3_u32 v13, v13, v133, v134
s_waitcnt vmcnt(17)
v_max3_u32 v13, v13, v135, v136
v_mfma_f32_16x16x32_bf16 v[120:123], v[188:191], v[24:27], v[120:123]
v_max3_u32 v13, v13, v137, v138
s_waitcnt vmcnt(16)
v_max3_u32 v13, v13, v139, v140
v_mfma_f32_16x16x32_bf16 v[76:79], v[176:179], v[28:31], v[76:79]
v_max3_u32 v13, v13, v141, v142
v_max_u32 v13, v13, v143
v_mfma_f32_16x16x32_bf16 v[92:95], v[180:183], v[28:31], v[92:95]
v_cmp_eq_u32 vcc, -1, v13
s_nop 0
s_cbranch_vccz L_hk4_ok
s_mov_b32 s59, 0x10000
s_add_u32 s78, s40, 0x4000
L_hk4_spin:
s_add_u32 s9, s78, s63
buffer_load_dwordx4 v[128:131], v1, s[44:47], s9 offen sc1
s_add_u32 s9, s78, s64
buffer_load_dwordx4 v[132:135], v1, s[44:47], s9 offen sc1
s_add_u32 s9, s78, s65
buffer_load_dwordx4 v[136:139], v1, s[44:47], s9 offen sc1
s_add_u32 s9, s78, s66
buffer_load_dwordx4 v[140:143], v1, s[44:47], s9 offen sc1
s_waitcnt vmcnt(0)
v_max3_u32 v13, v128, v129, v130
v_max3_u32 v13, v13, v131, v132
v_max3_u32 v13, v13, v133, v134
v_max3_u32 v13, v13, v135, v136
v_max3_u32 v13, v13, v137, v138
v_max3_u32 v13, v13, v139, v140
v_max3_u32 v13, v13, v141, v142
v_max_u32 v13, v13, v143
v_cmp_eq_u32 vcc, -1, v13
s_sub_u32 s59, s59, 1
s_cbranch_scc1 L_hk4_ok
s_cbranch_vccnz L_hk4_spin
L_hk4_ok:
v_mfma_f32_16x16x32_bf16 v[108:111], v[184:187], v[28:31], v[108:111]
v_mfma_f32_16x16x32_bf16 v[124:127], v[188:191], v[28:31], v[124:127]
v_mfma_f32_16x16x32_bf16 v[64:67], v[192:195], v[128:131], v[64:67]
s_add_u32 s76, s41, 0x8000
s_add_u32 s9, s76, s63
v_mfma_f32_16x16x32_bf16 v[80:83], v[196:199], v[128:131], v[80:83]
buffer_load_dwordx4 v[16:19], v1, s[44:47], s9 offen sc1
s_add_u32 s9, s76, s64
v_mfma_f32_16x16x32_bf16 v[96:99], v[200:203], v[128:131], v[96:99]
buffer_load_dwordx4 v[20:23], v1, s[44:47], s9 offen sc1
s_add_u32 s9, s76, s65
v_mfma_f32_16x16x32_bf16 v[112:115], v[204:207], v[128:131], v[112:115]
buffer_load_dwordx4 v[24:27], v1, s[44:47], s9 offen sc1
s_add_u32 s9, s76, s66
v_mfma_f32_16x16x32_bf16 v[68:71], v[192:195], v[132:135], v[68:71]
buffer_load_dwordx4 v[28:31], v1, s[44:47], s9 offen sc1
s_waitcnt vmcnt(19)
v_max3_u32 v13, v32, v33, v34
v_mfma_f32_16x16x32_bf16 v[84:87], v[196:199], v[132:135], v[84:87]
s_waitcnt vmcnt(18)
v_max3_u32 v13, v13, v35, v36
v_max3_u32 v13, v13, v37, v38
v_mfma_f32_16x16x32_bf16 v[100:103], v[200:203], v[132:135], v[100:103]
s_waitcnt vmcnt(17)
v_max3_u32 v13, v13, v39, v40
v_max3_u32 v13, v13, v41, v42
v_mfma_f32_16x16x32_bf16 v[116:119], v[204:207], v[132:135], v[116:119]
s_waitcnt vmcnt(16)
v_max3_u32 v13, v13, v43, v44
v_max3_u32 v13, v13, v45, v46
v_mfma_f32_16x16x32_bf16 v[72:75], v[192:195], v[136:139], v[72:75]
v_max_u32 v13, v13, v47
v_cmp_eq_u32 vcc, -1, v13
s_nop 0
s_cbranch_vccz L_hk5_ok
s_mov_b32 s59, 0x10000
s_add_u32 s78, s41, 0x4000
L_hk5_spin:
s_add_u32 s9, s78, s63
buffer_load_dwordx4 v[32:35], v1, s[44:47], s9 offen sc1
s_add_u32 s9, s78, s64
buffer_load_dwordx4 v[36:39], v1, s[44:47], s9 offen sc1
s_add_u32 s9, s78, s65
buffer_load_dwordx4 v[40:43], v1, s[44:47], s9 offen sc1
s_add_u32 s9, s78, s66
buffer_load_dwordx4 v[44:47], v1, s[44:47], s9 offen sc1
s_waitcnt vmcnt(0)
v_max3_u32 v13, v32, v33, v34
v_max3_u32 v13, v13, v35, v36
v_max3_u32 v13, v13, v37, v38
v_max3_u32 v13, v13, v39, v40
v_max3_u32 v13, v13, v41, v42
v_max3_u32 v13, v13, v43, v44
v_max3_u32 v13, v13, v45, v46
v_max_u32 v13, v13, v47
v_cmp_eq_u32 vcc, -1, v13
s_sub_u32 s59, s59, 1
s_cbranch_scc1 L_hk5_ok
s_cbranch_vccnz L_hk5_spin
L_hk5_ok:
v_mfma_f32_16x16x32_bf16 v[88:91], v[196:199], v[136:139], v[88:91]
v_mfma_f32_16x16x32_bf16 v[104:107], v[200:203], v[136:139], v[104:107]
v_mfma_f32_16x16x32_bf16 v[120:123], v[204:207], v[136:139], v[120:123]
v_mfma_f32_16x16x32_bf16 v[76:79], v[192:195], v[140:143], v[76:79]
v_mfma_f32_16x16x32_bf16 v[92:95], v[196:199], v[140:143], v[92:95]
v_mfma_f32_16x16x32_bf16 v[108:111], v[200:203], v[140:143], v[108:111]
v_mfma_f32_16x16x32_bf16 v[124:127], v[204:207], v[140:143], v[124:127]
v_mfma_f32_16x16x32_bf16 v[64:67], v[208:211], v[32:35], v[64:67]
s_add_u32 s77, s42, 0x8000
s_add_u32 s9, s77, s63
v_mfma_f32_16x16x32_bf16 v[80:83], v[212:215], v[32:35], v[80:83]
buffer_load_dwordx4 v[176:179], v1, s[44:47], s9 offen sc1
s_add_u32 s9, s77, s64
v_mfma_f32_16x16x32_bf16 v[96:99], v[216:219], v[32:35], v[96:99]
buffer_load_dwordx4 v[180:183], v1, s[44:47], s9 offen sc1
s_add_u32 s9, s77, s65
v_mfma_f32_16x16x32_bf16 v[112:115], v[220:223], v[32:35], v[112:115]
buffer_load_dwordx4 v[184:187], v1, s[44:47], s9 offen sc1
s_add_u32 s9, s77, s66
v_mfma_f32_16x16x32_bf16 v[68:71], v[208:211], v[36:39], v[68:71]
buffer_load_dwordx4 v[188:191], v1, s[44:47], s9 offen sc1
s_waitcnt vmcnt(19)
v_max3_u32 v13, v144, v145, v146
v_mfma_f32_16x16x32_bf16 v[84:87], v[212:215], v[36:39], v[84:87]
s_waitcnt vmcnt(18)
v_max3_u32 v13, v13, v147, v148
v_max3_u32 v13, v13, v149, v150
v_mfma_f32_16x16x32_bf16 v[100:103], v[216:219], v[36:39], v[100:103]
s_waitcnt vmcnt(17)
v_max3_u32 v13, v13, v151, v152
v_max3_u32 v13, v13, v153, v154
v_mfma_f32_16x16x32_bf16 v[116:119], v[220:223], v[36:39], v[116:119]
s_waitcnt vmcnt(16)
v_max3_u32 v13, v13, v155, v156
v_max3_u32 v13, v13, v157, v158
v_mfma_f32_16x16x32_bf16 v[72:75], v[208:211], v[40:43], v[72:75]
v_max_u32 v13, v13, v159
v_cmp_eq_u32 vcc, -1, v13
s_nop 0
s_cbranch_vccz L_hk6_ok
s_mov_b32 s59, 0x10000
s_add_u32 s78, s42, 0x4000
L_hk6_spin:
s_add_u32 s9, s78, s63
buffer_load_dwordx4 v[144:147], v1, s[44:47], s9 offen sc1
s_add_u32 s9, s78, s64
buffer_load_dwordx4 v[148:151], v1, s[44:47], s9 offen sc1
s_add_u32 s9, s78, s65
buffer_load_dwordx4 v[152:155], v1, s[44:47], s9 offen sc1
s_add_u32 s9, s78, s66
buffer_load_dwordx4 v[156:159], v1, s[44:47], s9 offen sc1
s_waitcnt vmcnt(0)
v_max3_u32 v13, v144, v145, v146
v_max3_u32 v13, v13, v147, v148
v_max3_u32 v13, v13, v149, v150
v_max3_u32 v13, v13, v151, v152
v_max3_u32 v13, v13, v153, v154
v_max3_u32 v13, v13, v155, v156
v_max3_u32 v13, v13, v157, v158
v_max_u32 v13, v13, v159
v_cmp_eq_u32 vcc, -1, v13
s_sub_u32 s59, s59, 1
s_cbranch_scc1 L_hk6_ok
s_cbranch_vccnz L_hk6_spin
L_hk6_ok:
v_mfma_f32_16x16x32_bf16 v[88:91], v[212:215], v[40:43], v[88:91]
v_mfma_f32_16x16x32_bf16 v[104:107], v[216:219], v[40:43], v[104:107]
v_mfma_f32_16x16x32_bf16 v[120:123], v[220:223], v[40:43], v[120:123]
v_mfma_f32_16x16x32_bf16 v[76:79], v[208:211], v[44:47], v[76:79]
v_mfma_f32_16x16x32_bf16 v[92:95], v[212:215], v[44:47], v[92:95]
v_mfma_f32_16x16x32_bf16 v[108:111], v[216:219], v[44:47], v[108:111]
v_mfma_f32_16x16x32_bf16 v[124:127], v[220:223], v[44:47], v[124:127]
v_mfma_f32_16x16x32_bf16 v[64:67], v[224:227], v[144:147], v[64:67]
s_add_u32 s76, s43, 0x8000
s_add_u32 s9, s76, s63
v_mfma_f32_16x16x32_bf16 v[80:83], v[228:231], v[144:147], v[80:83]
buffer_load_dwordx4 v[128:131], v1, s[44:47], s9 offen sc1
s_add_u32 s9, s76, s64
v_mfma_f32_16x16x32_bf16 v[96:99], v[232:235], v[144:147], v[96:99]
buffer_load_dwordx4 v[132:135], v1, s[44:47], s9 offen sc1
s_add_u32 s9, s76, s65
v_mfma_f32_16x16x32_bf16 v[112:115], v[236:239], v[144:147], v[112:115]
buffer_load_dwordx4 v[136:139], v1, s[44:47], s9 offen sc1
s_add_u32 s9, s76, s66
v_mfma_f32_16x16x32_bf16 v[68:71], v[224:227], v[148:151], v[68:71]
buffer_load_dwordx4 v[140:143], v1, s[44:47], s9 offen sc1
s_waitcnt vmcnt(19)
v_max3_u32 v13, v48, v49, v50
v_mfma_f32_16x16x32_bf16 v[84:87], v[228:231], v[148:151], v[84:87]
s_waitcnt vmcnt(18)
v_max3_u32 v13, v13, v51, v52
v_max3_u32 v13, v13, v53, v54
v_mfma_f32_16x16x32_bf16 v[100:103], v[232:235], v[148:151], v[100:103]
s_waitcnt vmcnt(17)
v_max3_u32 v13, v13, v55, v56
v_max3_u32 v13, v13, v57, v58
v_mfma_f32_16x16x32_bf16 v[116:119], v[236:239], v[148:151], v[116:119]
s_waitcnt vmcnt(16)
v_max3_u32 v13, v13, v59, v60
v_max3_u32 v13, v13, v61, v62
v_mfma_f32_16x16x32_bf16 v[72:75], v[224:227], v[152:155], v[72:75]
v_max_u32 v13, v13, v63
v_cmp_eq_u32 vcc, -1, v13
s_nop 0
s_cbranch_vccz L_hk7_ok
s_mov_b32 s59, 0x10000
s_add_u32 s78, s43, 0x4000
L_hk7_spin:
s_add_u32 s9, s78, s63
buffer_load_dwordx4 v[48:51], v1, s[44:47], s9 offen sc1
s_add_u32 s9, s78, s64
buffer_load_dwordx4 v[52:55], v1, s[44:47], s9 offen sc1
s_add_u32 s9, s78, s65
buffer_load_dwordx4 v[56:59], v1, s[44:47], s9 offen sc1
s_add_u32 s9, s78, s66
buffer_load_dwordx4 v[60:63], v1, s[44:47], s9 offen sc1
s_waitcnt vmcnt(0)
v_max3_u32 v13, v48, v49, v50
v_max3_u32 v13, v13, v51, v52
v_max3_u32 v13, v13, v53, v54
v_max3_u32 v13, v13, v55, v56
v_max3_u32 v13, v13, v57, v58
v_max3_u32 v13, v13, v59, v60
v_max3_u32 v13, v13, v61, v62
v_max_u32 v13, v13, v63
v_cmp_eq_u32 vcc, -1, v13
s_sub_u32 s59, s59, 1
s_cbranch_scc1 L_hk7_ok
s_cbranch_vccnz L_hk7_spin
L_hk7_ok:
v_mfma_f32_16x16x32_bf16 v[88:91], v[228:231], v[152:155], v[88:91]
v_mfma_f32_16x16x32_bf16 v[104:107], v[232:235], v[152:155], v[104:107]
v_mfma_f32_16x16x32_bf16 v[120:123], v[236:239], v[152:155], v[120:123]
v_mfma_f32_16x16x32_bf16 v[76:79], v[224:227], v[156:159], v[76:79]
v_mfma_f32_16x16x32_bf16 v[92:95], v[228:231], v[156:159], v[92:95]
v_mfma_f32_16x16x32_bf16 v[108:111], v[232:235], v[156:159], v[108:111]
v_mfma_f32_16x16x32_bf16 v[124:127], v[236:239], v[156:159], v[124:127]
v_mfma_f32_16x16x32_bf16 v[64:67], v[240:243], v[48:51], v[64:67]
s_add_u32 s78, s62, 0x1000
v_add_u32 v8, s78, v5
v_xor_b32 v9, 32, v8
v_mfma_f32_16x16x32_bf16 v[80:83], v[244:247], v[48:51], v[80:83]
v_xor_b32 v10, 64, v8
v_xor_b32 v11, 0x60, v8
ds_read_b64_tr_b16 v[192:193], v8
v_mfma_f32_16x16x32_bf16 v[96:99], v[248:251], v[48:51], v[96:99]
ds_read_b64_tr_b16 v[194:195], v8 offset:512
ds_read_b64_tr_b16 v[196:197], v9
ds_read_b64_tr_b16 v[198:199], v9 offset:512
v_mfma_f32_16x16x32_bf16 v[112:115], v[252:255], v[48:51], v[112:115]
ds_read_b64_tr_b16 v[200:201], v10
ds_read_b64_tr_b16 v[202:203], v10 offset:512
ds_read_b64_tr_b16 v[204:205], v11
v_mfma_f32_16x16x32_bf16 v[68:71], v[240:243], v[52:55], v[68:71]
ds_read_b64_tr_b16 v[206:207], v11 offset:512
s_add_u32 s77, s40, 0xc000
s_add_u32 s9, s77, s63
v_mfma_f32_16x16x32_bf16 v[84:87], v[244:247], v[52:55], v[84:87]
buffer_load_dwordx4 v[32:35], v1, s[44:47], s9 offen sc1
s_add_u32 s9, s77, s64
buffer_load_dwordx4 v[36:39], v1, s[44:47], s9 offen sc1
v_mfma_f32_16x16x32_bf16 v[100:103], v[248:251], v[52:55], v[100:103]
s_add_u32 s9, s77, s65
buffer_load_dwordx4 v[40:43], v1, s[44:47], s9 offen sc1
s_add_u32 s9, s77, s66
v_mfma_f32_16x16x32_bf16 v[116:119], v[252:255], v[52:55], v[116:119]
buffer_load_dwordx4 v[44:47], v1, s[44:47], s9 offen sc1
s_waitcnt vmcnt(19)
v_max3_u32 v13, v160, v161, v162
s_waitcnt vmcnt(18)
v_max3_u32 v13, v13, v163, v164
v_mfma_f32_16x16x32_bf16 v[72:75], v[240:243], v[56:59], v[72:75]
v_max3_u32 v13, v13, v165, v166
s_waitcnt vmcnt(17)
v_max3_u32 v13, v13, v167, v168
v_max3_u32 v13, v13, v169, v170
v_mfma_f32_16x16x32_bf16 v[88:91], v[244:247], v[56:59], v[88:91]
s_waitcnt vmcnt(16)
v_max3_u32 v13, v13, v171, v172
v_max3_u32 v13, v13, v173, v174
v_max_u32 v13, v13, v175
v_mfma_f32_16x16x32_bf16 v[104:107], v[248:251], v[56:59], v[104:107]
v_cmp_eq_u32 vcc, -1, v13
s_nop 0
s_cbranch_vccz L_hk8_ok
s_mov_b32 s59, 0x10000
s_add_u32 s78, s40, 0x8000
L_hk8_spin:
s_add_u32 s9, s78, s63
buffer_load_dwordx4 v[160:163], v1, s[44:47], s9 offen sc1
s_add_u32 s9, s78, s64
buffer_load_dwordx4 v[164:167], v1, s[44:47], s9 offen sc1
s_add_u32 s9, s78, s65
buffer_load_dwordx4 v[168:171], v1, s[44:47], s9 offen sc1
s_add_u32 s9, s78, s66
buffer_load_dwordx4 v[172:175], v1, s[44:47], s9 offen sc1
s_waitcnt vmcnt(0)
v_max3_u32 v13, v160, v161, v162
v_max3_u32 v13, v13, v163, v164
v_max3_u32 v13, v13, v165, v166
v_max3_u32 v13, v13, v167, v168
v_max3_u32 v13, v13, v169, v170
v_max3_u32 v13, v13, v171, v172
v_max3_u32 v13, v13, v173, v174
v_max_u32 v13, v13, v175
v_cmp_eq_u32 vcc, -1, v13
s_sub_u32 s59, s59, 1
s_cbranch_scc1 L_hk8_ok
s_cbranch_vccnz L_hk8_spin
L_hk8_ok:
v_mfma_f32_16x16x32_bf16 v[120:123], v[252:255], v[56:59], v[120:123]
v_mfma_f32_16x16x32_bf16 v[76:79], v[240:243], v[60:63], v[76:79]
v_mfma_f32_16x16x32_bf16 v[92:95], v[244:247], v[60:63], v[92:95]
v_mfma_f32_16x16x32_bf16 v[108:111], v[248:251], v[60:63], v[108:111]
v_mfma_f32_16x16x32_bf16 v[124:127], v[252:255], v[60:63], v[124:127]
s_waitcnt lgkmcnt(6)
v_mfma_f32_16x16x32_bf16 v[64:67], v[192:195], v[160:163], v[64:67]
s_add_u32 s78, s62, 0x2000
v_add_u32 v8, s78, v5
v_xor_b32 v9, 32, v8
s_waitcnt lgkmcnt(4)
v_mfma_f32_16x16x32_bf16 v[80:83], v[196:199], v[160:163], v[80:83]
v_xor_b32 v10, 64, v8
v_xor_b32 v11, 0x60, v8
ds_read_b64_tr_b16 v[208:209], v8
s_waitcnt lgkmcnt(3)
v_mfma_f32_16x16x32_bf16 v[96:99], v[200:203], v[160:163], v[96:99]
ds_read_b64_tr_b16 v[210:211], v8 offset:512
ds_read_b64_tr_b16 v[212:213], v9
ds_read_b64_tr_b16 v[214:215], v9 offset:512
s_waitcnt lgkmcnt(4)
v_mfma_f32_16x16x32_bf16 v[112:115], v[204:207], v[160:163], v[112:115]
ds_read_b64_tr_b16 v[216:217], v10
ds_read_b64_tr_b16 v[218:219], v10 offset:512
ds_read_b64_tr_b16 v[220:221], v11
v_mfma_f32_16x16x32_bf16 v[68:71], v[192:195], v[164:167], v[68:71]
ds_read_b64_tr_b16 v[222:223], v11 offset:512
s_add_u32 s76, s41, 0xc000
s_add_u32 s9, s76, s63
v_mfma_f32_16x16x32_bf16 v[84:87], v[196:199], v[164:167], v[84:87]
buffer_load_dwordx4 v[144:147], v1, s[44:47], s9 offen sc1
s_add_u32 s9, s76, s64
buffer_load_dwordx4 v[148:151], v1, s[44:47], s9 offen sc1
v_mfma_f32_16x16x32_bf16 v[100:103], v[200:203], v[164:167], v[100:103]
s_add_u32 s9, s76, s65
buffer_load_dwordx4 v[152:155], v1, s[44:47], s9 offen sc1
s_add_u32 s9, s76, s66
v_mfma_f32_16x16x32_bf16 v[116:119], v[204:207], v[164:167], v[116:119]
buffer_load_dwordx4 v[156:159], v1, s[44:47], s9 offen sc1
s_waitcnt vmcnt(19)
v_max3_u32 v13, v16, v17, v18
s_waitcnt vmcnt(18)
v_max3_u32 v13, v13, v19, v20
v_mfma_f32_16x16x32_bf16 v[72:75], v[192:195], v[168:171], v[72:75]
v_max3_u32 v13, v13, v21, v22
s_waitcnt vmcnt(17)
v_max3_u32 v13, v13, v23, v24
v_max3_u32 v13, v13, v25, v26
v_mfma_f32_16x16x32_bf16 v[88:91], v[196:199], v[168:171], v[88:91]
s_waitcnt vmcnt(16)
v_max3_u32 v13, v13, v27, v28
v_max3_u32 v13, v13, v29, v30
v_max_u32 v13, v13, v31
v_mfma_f32_16x16x32_bf16 v[104:107], v[200:203], v[168:171], v[104:107]
v_cmp_eq_u32 vcc, -1, v13
s_nop 0
s_cbranch_vccz L_hk9_ok
s_mov_b32 s59, 0x10000
s_add_u32 s78, s41, 0x8000
L_hk9_spin:
s_add_u32 s9, s78, s63
buffer_load_dwordx4 v[16:19], v1, s[44:47], s9 offen sc1
s_add_u32 s9, s78, s64
buffer_load_dwordx4 v[20:23], v1, s[44:47], s9 offen sc1
s_add_u32 s9, s78, s65
buffer_load_dwordx4 v[24:27], v1, s[44:47], s9 offen sc1
s_add_u32 s9, s78, s66
buffer_load_dwordx4 v[28:31], v1, s[44:47], s9 offen sc1
s_waitcnt vmcnt(0)
v_max3_u32 v13, v16, v17, v18
v_max3_u32 v13, v13, v19, v20
v_max3_u32 v13, v13, v21, v22
v_max3_u32 v13, v13, v23, v24
v_max3_u32 v13, v13, v25, v26
v_max3_u32 v13, v13, v27, v28
v_max3_u32 v13, v13, v29, v30
v_max_u32 v13, v13, v31
v_cmp_eq_u32 vcc, -1, v13
s_sub_u32 s59, s59, 1
s_cbranch_scc1 L_hk9_ok
s_cbranch_vccnz L_hk9_spin
L_hk9_ok:
v_mfma_f32_16x16x32_bf16 v[120:123], v[204:207], v[168:171], v[120:123]
v_mfma_f32_16x16x32_bf16 v[76:79], v[192:195], v[172:175], v[76:79]
v_mfma_f32_16x16x32_bf16 v[92:95], v[196:199], v[172:175], v[92:95]
v_mfma_f32_16x16x32_bf16 v[108:111], v[200:203], v[172:175], v[108:111]
v_mfma_f32_16x16x32_bf16 v[124:127], v[204:207], v[172:175], v[124:127]
s_waitcnt lgkmcnt(6)
v_mfma_f32_16x16x32_bf16 v[64:67], v[208:211], v[16:19], v[64:67]
s_add_u32 m0, s62, 0x1000
s_add_u32 s77, s83, 0
buffer_load_dwordx4 v2, s[28:31], s77 offen lds
s_waitcnt lgkmcnt(4)
v_mfma_f32_16x16x32_bf16 v[80:83], v[212:215], v[16:19], v[80:83]
buffer_load_dwordx4 v3, s[28:31], s77 offen offset:1024 lds
buffer_load_dwordx4 v4, s[28:31], s77 offen offset:2048 lds
buffer_load_dwordx4 v14, s[28:31], s77 offen offset:3072 lds
s_waitcnt lgkmcnt(2)
v_mfma_f32_16x16x32_bf16 v[96:99], v[216:219], v[16:19], v[96:99]
s_add_u32 s78, s62, 0x3000
v_add_u32 v8, s78, v5
v_xor_b32 v9, 32, v8
s_waitcnt lgkmcnt(0)
v_mfma_f32_16x16x32_bf16 v[112:115], v[220:223], v[16:19], v[112:115]
v_xor_b32 v10, 64, v8
v_xor_b32 v11, 0x60, v8
ds_read_b64_tr_b16 v[224:225], v8
v_mfma_f32_16x16x32_bf16 v[68:71], v[208:211], v[20:23], v[68:71]
ds_read_b64_tr_b16 v[226:227], v8 offset:512
ds_read_b64_tr_b16 v[228:229], v9
ds_read_b64_tr_b16 v[230:231], v9 offset:512
v_mfma_f32_16x16x32_bf16 v[84:87], v[212:215], v[20:23], v[84:87]
ds_read_b64_tr_b16 v[232:233], v10
ds_read_b64_tr_b16 v[234:235], v10 offset:512
ds_read_b64_tr_b16 v[236:237], v11
v_mfma_f32_16x16x32_bf16 v[100:103], v[216:219], v[20:23], v[100:103]
ds_read_b64_tr_b16 v[238:239], v11 offset:512
s_add_u32 s76, s42, 0xc000
s_add_u32 s9, s76, s63
v_mfma_f32_16x16x32_bf16 v[116:119], v[220:223], v[20:23], v[116:119]
buffer_load_dwordx4 v[48:51], v1, s[44:47], s9 offen sc1
s_add_u32 s9, s76, s64
buffer_load_dwordx4 v[52:55], v1, s[44:47], s9 offen sc1
v_mfma_f32_16x16x32_bf16 v[72:75], v[208:211], v[24:27], v[72:75]
s_add_u32 s9, s76, s65
buffer_load_dwordx4 v[56:59], v1, s[44:47], s9 offen sc1
s_add_u32 s9, s76, s66
v_mfma_f32_16x16x32_bf16 v[88:91], v[212:215], v[24:27], v[88:91]
buffer_load_dwordx4 v[60:63], v1, s[44:47], s9 offen sc1
s_waitcnt vmcnt(23)
v_max3_u32 v13, v176, v177, v178
s_waitcnt vmcnt(22)
v_max3_u32 v13, v13, v179, v180
v_mfma_f32_16x16x32_bf16 v[104:107], v[216:219], v[24:27], v[104:107]
v_max3_u32 v13, v13, v181, v182
s_waitcnt vmcnt(21)
v_max3_u32 v13, v13, v183, v184
v_max3_u32 v13, v13, v185, v186
v_mfma_f32_16x16x32_bf16 v[120:123], v[220:223], v[24:27], v[120:123]
s_waitcnt vmcnt(20)
v_max3_u32 v13, v13, v187, v188
v_max3_u32 v13, v13, v189, v190
v_max_u32 v13, v13, v191
v_mfma_f32_16x16x32_bf16 v[76:79], v[208:211], v[28:31], v[76:79]
v_cmp_eq_u32 vcc, -1, v13
s_nop 0
s_cbranch_vccz L_hk10_ok
s_mov_b32 s59, 0x10000
s_add_u32 s78, s42, 0x8000
L_hk10_spin:
s_add_u32 s9, s78, s63
buffer_load_dwordx4 v[176:179], v1, s[44:47], s9 offen sc1
s_add_u32 s9, s78, s64
buffer_load_dwordx4 v[180:183], v1, s[44:47], s9 offen sc1
s_add_u32 s9, s78, s65
buffer_load_dwordx4 v[184:187], v1, s[44:47], s9 offen sc1
s_add_u32 s9, s78, s66
buffer_load_dwordx4 v[188:191], v1, s[44:47], s9 offen sc1
s_waitcnt vmcnt(0)
v_max3_u32 v13, v176, v177, v178
v_max3_u32 v13, v13, v179, v180
v_max3_u32 v13, v13, v181, v182
v_max3_u32 v13, v13, v183, v184
v_max3_u32 v13, v13, v185, v186
v_max3_u32 v13, v13, v187, v188
v_max3_u32 v13, v13, v189, v190
v_max_u32 v13, v13, v191
v_cmp_eq_u32 vcc, -1, v13
s_sub_u32 s59, s59, 1
s_cbranch_scc1 L_hk10_ok
s_cbranch_vccnz L_hk10_spin
L_hk10_ok:
v_mfma_f32_16x16x32_bf16 v[92:95], v[212:215], v[28:31], v[92:95]
v_mfma_f32_16x16x32_bf16 v[108:111], v[216:219], v[28:31], v[108:111]
v_mfma_f32_16x16x32_bf16 v[124:127], v[220:223], v[28:31], v[124:127]
s_waitcnt lgkmcnt(6)
v_mfma_f32_16x16x32_bf16 v[64:67], v[224:227], v[176:179], v[64:67]
s_add_u32 s78, s62, 0
v_add_u32 v8, s78, v5
v_xor_b32 v9, 32, v8
s_waitcnt lgkmcnt(4)
v_mfma_f32_16x16x32_bf16 v[80:83], v[228:231], v[176:179], v[80:83]
v_xor_b32 v10, 64, v8
v_xor_b32 v11, 0x60, v8
ds_read_b64_tr_b16 v[240:241], v8
s_waitcnt lgkmcnt(3)
v_mfma_f32_16x16x32_bf16 v[96:99], v[232:235], v[176:179], v[96:99]
ds_read_b64_tr_b16 v[242:243], v8 offset:512
ds_read_b64_tr_b16 v[244:245], v9
ds_read_b64_tr_b16 v[246:247], v9 offset:512
s_waitcnt lgkmcnt(4)
v_mfma_f32_16x16x32_bf16 v[112:115], v[236:239], v[176:179], v[112:115]
ds_read_b64_tr_b16 v[248:249], v10
ds_read_b64_tr_b16 v[250:251], v10 offset:512
ds_read_b64_tr_b16 v[252:253], v11
v_mfma_f32_16x16x32_bf16 v[68:71], v[224:227], v[180:183], v[68:71]
ds_read_b64_tr_b16 v[254:255], v11 offset:512
s_add_u32 s77, s43, 0xc000
s_add_u32 s9, s77, s63
v_mfma_f32_16x16x32_bf16 v[84:87], v[228:231], v[180:183], v[84:87]
buffer_load_dwordx4 v[160:163], v1, s[44:47], s9 offen sc1
s_add_u32 s9, s77, s64
buffer_load_dwordx4 v[164:167], v1, s[44:47], s9 offen sc1
v_mfma_f32_16x16x32_bf16 v[100:103], v[232:235], v[180:183], v[100:103]
s_add_u32 s9, s77, s65
buffer_load_dwordx4 v[168:171], v1, s[44:47], s9 offen sc1
s_add_u32 s9, s77, s66
v_mfma_f32_16x16x32_bf16 v[116:119], v[236:239], v[180:183], v[116:119]
buffer_load_dwordx4 v[172:175], v1, s[44:47], s9 offen sc1
s_waitcnt vmcnt(23)
v_max3_u32 v13, v128, v129, v130
s_waitcnt vmcnt(22)
v_max3_u32 v13, v13, v131, v132
v_mfma_f32_16x16x32_bf16 v[72:75], v[224:227], v[184:187], v[72:75]
v_max3_u32 v13, v13, v133, v134
s_waitcnt vmcnt(21)
v_max3_u32 v13, v13, v135, v136
v_max3_u32 v13, v13, v137, v138
v_mfma_f32_16x16x32_bf16 v[88:91], v[228:231], v[184:187], v[88:91]
s_waitcnt vmcnt(20)
v_max3_u32 v13, v13, v139, v140
v_max3_u32 v13, v13, v141, v142
v_max_u32 v13, v13, v143
v_mfma_f32_16x16x32_bf16 v[104:107], v[232:235], v[184:187], v[104:107]
v_cmp_eq_u32 vcc, -1, v13
s_nop 0
s_cbranch_vccz L_hk11_ok
s_mov_b32 s59, 0x10000
s_add_u32 s78, s43, 0x8000
L_hk11_spin:
s_add_u32 s9, s78, s63
buffer_load_dwordx4 v[128:131], v1, s[44:47], s9 offen sc1
s_add_u32 s9, s78, s64
buffer_load_dwordx4 v[132:135], v1, s[44:47], s9 offen sc1
s_add_u32 s9, s78, s65
buffer_load_dwordx4 v[136:139], v1, s[44:47], s9 offen sc1
s_add_u32 s9, s78, s66
buffer_load_dwordx4 v[140:143], v1, s[44:47], s9 offen sc1
s_waitcnt vmcnt(0)
v_max3_u32 v13, v128, v129, v130
v_max3_u32 v13, v13, v131, v132
v_max3_u32 v13, v13, v133, v134
v_max3_u32 v13, v13, v135, v136
v_max3_u32 v13, v13, v137, v138
v_max3_u32 v13, v13, v139, v140
v_max3_u32 v13, v13, v141, v142
v_max_u32 v13, v13, v143
v_cmp_eq_u32 vcc, -1, v13
s_sub_u32 s59, s59, 1
s_cbranch_scc1 L_hk11_ok
s_cbranch_vccnz L_hk11_spin
L_hk11_ok:
v_mfma_f32_16x16x32_bf16 v[120:123], v[236:239], v[184:187], v[120:123]
v_mfma_f32_16x16x32_bf16 v[76:79], v[224:227], v[188:191], v[76:79]
v_mfma_f32_16x16x32_bf16 v[92:95], v[228:231], v[188:191], v[92:95]
v_mfma_f32_16x16x32_bf16 v[108:111], v[232:235], v[188:191], v[108:111]
v_mfma_f32_16x16x32_bf16 v[124:127], v[236:239], v[188:191], v[124:127]
s_waitcnt lgkmcnt(6)
v_mfma_f32_16x16x32_bf16 v[64:67], v[240:243], v[128:131], v[64:67]
s_add_u32 s78, s75, 0xc000
v_add_u32 v8, s78, v7
v_xor_b32 v9, 32, v8
s_waitcnt lgkmcnt(4)
v_mfma_f32_16x16x32_bf16 v[80:83], v[244:247], v[128:131], v[80:83]
v_xor_b32 v10, 64, v8
v_xor_b32 v11, 0x60, v8
ds_read_b64_tr_b16 v[192:193], v8
s_waitcnt lgkmcnt(3)
v_mfma_f32_16x16x32_bf16 v[96:99], v[248:251], v[128:131], v[96:99]
ds_read_b64_tr_b16 v[194:195], v8 offset:256
ds_read_b64_tr_b16 v[196:197], v9
ds_read_b64_tr_b16 v[198:199], v9 offset:256
s_waitcnt lgkmcnt(4)
v_mfma_f32_16x16x32_bf16 v[112:115], v[252:255], v[128:131], v[112:115]
ds_read_b64_tr_b16 v[200:201], v10
ds_read_b64_tr_b16 v[202:203], v10 offset:256
ds_read_b64_tr_b16 v[204:205], v11
v_mfma_f32_16x16x32_bf16 v[68:71], v[240:243], v[132:135], v[68:71]
ds_read_b64_tr_b16 v[206:207], v11 offset:256
s_add_u32 s76, s84, 0x10000
s_add_u32 s9, s76, s63
v_mfma_f32_16x16x32_bf16 v[84:87], v[244:247], v[132:135], v[84:87]
buffer_load_dwordx4 v[16:19], v1, s[44:47], s9 offen sc1
s_add_u32 s9, s76, s64
buffer_load_dwordx4 v[20:23], v1, s[44:47], s9 offen sc1
v_mfma_f32_16x16x32_bf16 v[100:103], v[248:251], v[132:135], v[100:103]
s_add_u32 s9, s76, s65
buffer_load_dwordx4 v[24:27], v1, s[44:47], s9 offen sc1
s_add_u32 s9, s76, s66
v_mfma_f32_16x16x32_bf16 v[116:119], v[252:255], v[132:135], v[116:119]
buffer_load_dwordx4 v[28:31], v1, s[44:47], s9 offen sc1
s_waitcnt vmcnt(23)
v_max3_u32 v13, v32, v33, v34
s_waitcnt vmcnt(22)
v_max3_u32 v13, v13, v35, v36
v_mfma_f32_16x16x32_bf16 v[72:75], v[240:243], v[136:139], v[72:75]
v_max3_u32 v13, v13, v37, v38
s_waitcnt vmcnt(21)
v_max3_u32 v13, v13, v39, v40
v_max3_u32 v13, v13, v41, v42
v_mfma_f32_16x16x32_bf16 v[88:91], v[244:247], v[136:139], v[88:91]
s_waitcnt vmcnt(20)
v_max3_u32 v13, v13, v43, v44
v_max3_u32 v13, v13, v45, v46
v_max_u32 v13, v13, v47
v_mfma_f32_16x16x32_bf16 v[104:107], v[248:251], v[136:139], v[104:107]
v_cmp_eq_u32 vcc, -1, v13
s_nop 0
s_cbranch_vccz L_hk12_ok
s_mov_b32 s59, 0x10000
s_add_u32 s78, s40, 0xc000
L_hk12_spin:
s_add_u32 s9, s78, s63
buffer_load_dwordx4 v[32:35], v1, s[44:47], s9 offen sc1
s_add_u32 s9, s78, s64
buffer_load_dwordx4 v[36:39], v1, s[44:47], s9 offen sc1
s_add_u32 s9, s78, s65
buffer_load_dwordx4 v[40:43], v1, s[44:47], s9 offen sc1
s_add_u32 s9, s78, s66
buffer_load_dwordx4 v[44:47], v1, s[44:47], s9 offen sc1
s_waitcnt vmcnt(0)
v_max3_u32 v13, v32, v33, v34
v_max3_u32 v13, v13, v35, v36
v_max3_u32 v13, v13, v37, v38
v_max3_u32 v13, v13, v39, v40
v_max3_u32 v13, v13, v41, v42
v_max3_u32 v13, v13, v43, v44
v_max3_u32 v13, v13, v45, v46
v_max_u32 v13, v13, v47
v_cmp_eq_u32 vcc, -1, v13
s_sub_u32 s59, s59, 1
s_cbranch_scc1 L_hk12_ok
s_cbranch_vccnz L_hk12_spin
L_hk12_ok:
v_mfma_f32_16x16x32_bf16 v[120:123], v[252:255], v[136:139], v[120:123]
v_mfma_f32_16x16x32_bf16 v[76:79], v[240:243], v[140:143], v[76:79]
v_mfma_f32_16x16x32_bf16 v[92:95], v[244:247], v[140:143], v[92:95]
v_mfma_f32_16x16x32_bf16 v[108:111], v[248:251], v[140:143], v[108:111]
v_mfma_f32_16x16x32_bf16 v[124:127], v[252:255], v[140:143], v[124:127]
s_waitcnt lgkmcnt(6)
v_mfma_f32_16x16x32_bf16 v[64:67], v[192:195], v[32:35], v[64:67]
s_add_u32 s78, s75, 0x10000
v_add_u32 v8, s78, v7
v_xor_b32 v9, 32, v8
s_waitcnt lgkmcnt(4)
v_mfma_f32_16x16x32_bf16 v[80:83], v[196:199], v[32:35], v[80:83]
v_xor_b32 v10, 64, v8
v_xor_b32 v11, 0x60, v8
ds_read_b64_tr_b16 v[208:209], v8
s_waitcnt lgkmcnt(3)
v_mfma_f32_16x16x32_bf16 v[96:99], v[200:203], v[32:35], v[96:99]
ds_read_b64_tr_b16 v[210:211], v8 offset:256
ds_read_b64_tr_b16 v[212:213], v9
ds_read_b64_tr_b16 v[214:215], v9 offset:256
s_waitcnt lgkmcnt(4)
v_mfma_f32_16x16x32_bf16 v[112:115], v[204:207], v[32:35], v[112:115]
ds_read_b64_tr_b16 v[216:217], v10
ds_read_b64_tr_b16 v[218:219], v10 offset:256
ds_read_b64_tr_b16 v[220:221], v11
v_mfma_f32_16x16x32_bf16 v[68:71], v[192:195], v[36:39], v[68:71]
ds_read_b64_tr_b16 v[222:223], v11 offset:256
s_add_u32 s77, s85, 0x10000
s_add_u32 s9, s77, s63
v_mfma_f32_16x16x32_bf16 v[84:87], v[196:199], v[36:39], v[84:87]
buffer_load_dwordx4 v[176:179], v1, s[44:47], s9 offen sc1
s_add_u32 s9, s77, s64
buffer_load_dwordx4 v[180:183], v1, s[44:47], s9 offen sc1
v_mfma_f32_16x16x32_bf16 v[100:103], v[200:203], v[36:39], v[100:103]
s_add_u32 s9, s77, s65
buffer_load_dwordx4 v[184:187], v1, s[44:47], s9 offen sc1
s_add_u32 s9, s77, s66
v_mfma_f32_16x16x32_bf16 v[116:119], v[204:207], v[36:39], v[116:119]
buffer_load_dwordx4 v[188:191], v1, s[44:47], s9 offen sc1
s_waitcnt vmcnt(23)
v_max3_u32 v13, v144, v145, v146
s_waitcnt vmcnt(22)
v_max3_u32 v13, v13, v147, v148
v_mfma_f32_16x16x32_bf16 v[72:75], v[192:195], v[40:43], v[72:75]
v_max3_u32 v13, v13, v149, v150
s_waitcnt vmcnt(21)
v_max3_u32 v13, v13, v151, v152
v_max3_u32 v13, v13, v153, v154
v_mfma_f32_16x16x32_bf16 v[88:91], v[196:199], v[40:43], v[88:91]
s_waitcnt vmcnt(20)
v_max3_u32 v13, v13, v155, v156
v_max3_u32 v13, v13, v157, v158
v_max_u32 v13, v13, v159
v_mfma_f32_16x16x32_bf16 v[104:107], v[200:203], v[40:43], v[104:107]
v_cmp_eq_u32 vcc, -1, v13
s_nop 0
s_cbranch_vccz L_hk13_ok
s_mov_b32 s59, 0x10000
s_add_u32 s78, s41, 0xc000
L_hk13_spin:
s_add_u32 s9, s78, s63
buffer_load_dwordx4 v[144:147], v1, s[44:47], s9 offen sc1
s_add_u32 s9, s78, s64
buffer_load_dwordx4 v[148:151], v1, s[44:47], s9 offen sc1
s_add_u32 s9, s78, s65
buffer_load_dwordx4 v[152:155], v1, s[44:47], s9 offen sc1
s_add_u32 s9, s78, s66
buffer_load_dwordx4 v[156:159], v1, s[44:47], s9 offen sc1
s_waitcnt vmcnt(0)
v_max3_u32 v13, v144, v145, v146
v_max3_u32 v13, v13, v147, v148
v_max3_u32 v13, v13, v149, v150
v_max3_u32 v13, v13, v151, v152
v_max3_u32 v13, v13, v153, v154
v_max3_u32 v13, v13, v155, v156
v_max3_u32 v13, v13, v157, v158
v_max_u32 v13, v13, v159
v_cmp_eq_u32 vcc, -1, v13
s_sub_u32 s59, s59, 1
s_cbranch_scc1 L_hk13_ok
s_cbranch_vccnz L_hk13_spin
L_hk13_ok:
v_mfma_f32_16x16x32_bf16 v[120:123], v[204:207], v[40:43], v[120:123]
v_mfma_f32_16x16x32_bf16 v[76:79], v[192:195], v[44:47], v[76:79]
v_mfma_f32_16x16x32_bf16 v[92:95], v[196:199], v[44:47], v[92:95]
v_mfma_f32_16x16x32_bf16 v[108:111], v[200:203], v[44:47], v[108:111]
v_mfma_f32_16x16x32_bf16 v[124:127], v[204:207], v[44:47], v[124:127]
s_waitcnt lgkmcnt(6)
v_mfma_f32_16x16x32_bf16 v[64:67], v[208:211], v[144:147], v[64:67]
s_add_u32 s78, s75, 0
v_add_u32 v8, s78, v7
s_waitcnt lgkmcnt(4)
v_mfma_f32_16x16x32_bf16 v[80:83], v[212:215], v[144:147], v[80:83]
v_xor_b32 v9, 32, v8
v_xor_b32 v10, 64, v8
s_waitcnt lgkmcnt(2)
v_mfma_f32_16x16x32_bf16 v[96:99], v[216:219], v[144:147], v[96:99]
v_xor_b32 v11, 0x60, v8
ds_read_b64_tr_b16 v[224:225], v8
s_waitcnt lgkmcnt(1)
v_mfma_f32_16x16x32_bf16 v[112:115], v[220:223], v[144:147], v[112:115]
ds_read_b64_tr_b16 v[226:227], v8 offset:256
ds_read_b64_tr_b16 v[228:229], v9
v_mfma_f32_16x16x32_bf16 v[68:71], v[208:211], v[148:151], v[68:71]
ds_read_b64_tr_b16 v[230:231], v9 offset:256
ds_read_b64_tr_b16 v[232:233], v10
v_mfma_f32_16x16x32_bf16 v[84:87], v[212:215], v[148:151], v[84:87]
ds_read_b64_tr_b16 v[234:235], v10 offset:256
ds_read_b64_tr_b16 v[236:237], v11
v_mfma_f32_16x16x32_bf16 v[100:103], v[216:219], v[148:151], v[100:103]
ds_read_b64_tr_b16 v[238:239], v11 offset:256
s_waitcnt vmcnt(15)
v_max3_u32 v13, v48, v49, v50
v_mfma_f32_16x16x32_bf16 v[116:119], v[220:223], v[148:151], v[116:119]
s_waitcnt vmcnt(14)
v_max3_u32 v13, v13, v51, v52
v_max3_u32 v13, v13, v53, v54
v_mfma_f32_16x16x32_bf16 v[72:75], v[208:211], v[152:155], v[72:75]
s_waitcnt vmcnt(13)
v_max3_u32 v13, v13, v55, v56
v_max3_u32 v13, v13, v57, v58
v_mfma_f32_16x16x32_bf16 v[88:91], v[212:215], v[152:155], v[88:91]
s_waitcnt vmcnt(12)
v_max3_u32 v13, v13, v59, v60
v_max3_u32 v13, v13, v61, v62
v_mfma_f32_16x16x32_bf16 v[104:107], v[216:219], v[152:155], v[104:107]
v_max_u32 v13, v13, v63
v_cmp_eq_u32 vcc, -1, v13
s_nop 0
s_cbranch_vccz L_hk14_ok
s_mov_b32 s59, 0x10000
s_add_u32 s78, s42, 0xc000
L_hk14_spin:
s_add_u32 s9, s78, s63
buffer_load_dwordx4 v[48:51], v1, s[44:47], s9 offen sc1
s_add_u32 s9, s78, s64
buffer_load_dwordx4 v[52:55], v1, s[44:47], s9 offen sc1
s_add_u32 s9, s78, s65
buffer_load_dwordx4 v[56:59], v1, s[44:47], s9 offen sc1
s_add_u32 s9, s78, s66
buffer_load_dwordx4 v[60:63], v1, s[44:47], s9 offen sc1
s_waitcnt vmcnt(0)
v_max3_u32 v13, v48, v49, v50
v_max3_u32 v13, v13, v51, v52
v_max3_u32 v13, v13, v53, v54
v_max3_u32 v13, v13, v55, v56
v_max3_u32 v13, v13, v57, v58
v_max3_u32 v13, v13, v59, v60
v_max3_u32 v13, v13, v61, v62
v_max_u32 v13, v13, v63
v_cmp_eq_u32 vcc, -1, v13
s_sub_u32 s59, s59, 1
s_cbranch_scc1 L_hk14_ok
s_cbranch_vccnz L_hk14_spin
L_hk14_ok:
v_mfma_f32_16x16x32_bf16 v[120:123], v[220:223], v[152:155], v[120:123]
v_mfma_f32_16x16x32_bf16 v[76:79], v[208:211], v[156:159], v[76:79]
v_mfma_f32_16x16x32_bf16 v[92:95], v[212:215], v[156:159], v[92:95]
v_mfma_f32_16x16x32_bf16 v[108:111], v[216:219], v[156:159], v[108:111]
v_mfma_f32_16x16x32_bf16 v[124:127], v[220:223], v[156:159], v[124:127]
s_waitcnt lgkmcnt(6)
v_mfma_f32_16x16x32_bf16 v[64:67], v[224:227], v[48:51], v[64:67]
s_add_u32 s78, s75, 0x4000
v_add_u32 v8, s78, v7
s_waitcnt lgkmcnt(4)
v_mfma_f32_16x16x32_bf16 v[80:83], v[228:231], v[48:51], v[80:83]
v_xor_b32 v9, 32, v8
v_xor_b32 v10, 64, v8
s_waitcnt lgkmcnt(2)
v_mfma_f32_16x16x32_bf16 v[96:99], v[232:235], v[48:51], v[96:99]
v_xor_b32 v11, 0x60, v8
ds_read_b64_tr_b16 v[128:129], v8
s_waitcnt lgkmcnt(1)
v_mfma_f32_16x16x32_bf16 v[112:115], v[236:239], v[48:51], v[112:115]
ds_read_b64_tr_b16 v[130:131], v8 offset:256
ds_read_b64_tr_b16 v[132:133], v9
v_mfma_f32_16x16x32_bf16 v[68:71], v[224:227], v[52:55], v[68:71]
ds_read_b64_tr_b16 v[134:135], v9 offset:256
ds_read_b64_tr_b16 v[136:137], v10
v_mfma_f32_16x16x32_bf16 v[84:87], v[228:231], v[52:55], v[84:87]
ds_read_b64_tr_b16 v[138:139], v10 offset:256
ds_read_b64_tr_b16 v[140:141], v11
v_mfma_f32_16x16x32_bf16 v[100:103], v[232:235], v[52:55], v[100:103]
ds_read_b64_tr_b16 v[142:143], v11 offset:256
s_waitcnt vmcnt(11)
v_max3_u32 v13, v160, v161, v162
v_mfma_f32_16x16x32_bf16 v[116:119], v[236:239], v[52:55], v[116:119]
s_waitcnt vmcnt(10)
v_max3_u32 v13, v13, v163, v164
v_max3_u32 v13, v13, v165, v166
v_mfma_f32_16x16x32_bf16 v[72:75], v[224:227], v[56:59], v[72:75]
s_waitcnt vmcnt(9)
v_max3_u32 v13, v13, v167, v168
v_max3_u32 v13, v13, v169, v170
v_mfma_f32_16x16x32_bf16 v[88:91], v[228:231], v[56:59], v[88:91]
s_waitcnt vmcnt(8)
v_max3_u32 v13, v13, v171, v172
v_max3_u32 v13, v13, v173, v174
v_mfma_f32_16x16x32_bf16 v[104:107], v[232:235], v[56:59], v[104:107]
v_max_u32 v13, v13, v175
v_cmp_eq_u32 vcc, -1, v13
s_nop 0
s_cbranch_vccz L_hk15_ok
s_mov_b32 s59, 0x10000
s_add_u32 s78, s43, 0xc000
L_hk15_spin:
s_add_u32 s9, s78, s63
buffer_load_dwordx4 v[160:163], v1, s[44:47], s9 offen sc1
s_add_u32 s9, s78, s64
buffer_load_dwordx4 v[164:167], v1, s[44:47], s9 offen sc1
s_add_u32 s9, s78, s65
buffer_load_dwordx4 v[168:171], v1, s[44:47], s9 offen sc1
s_add_u32 s9, s78, s66
buffer_load_dwordx4 v[172:175], v1, s[44:47], s9 offen sc1
s_waitcnt vmcnt(0)
v_max3_u32 v13, v160, v161, v162
v_max3_u32 v13, v13, v163, v164
v_max3_u32 v13, v13, v165, v166
v_max3_u32 v13, v13, v167, v168
v_max3_u32 v13, v13, v169, v170
v_max3_u32 v13, v13, v171, v172
v_max3_u32 v13, v13, v173, v174
v_max_u32 v13, v13, v175
v_cmp_eq_u32 vcc, -1, v13
s_sub_u32 s59, s59, 1
s_cbranch_scc1 L_hk15_ok
s_cbranch_vccnz L_hk15_spin
L_hk15_ok:
v_mfma_f32_16x16x32_bf16 v[120:123], v[236:239], v[56:59], v[120:123]
v_mfma_f32_16x16x32_bf16 v[76:79], v[224:227], v[60:63], v[76:79]
v_mfma_f32_16x16x32_bf16 v[92:95], v[228:231], v[60:63], v[92:95]
v_mfma_f32_16x16x32_bf16 v[108:111], v[232:235], v[60:63], v[108:111]
v_mfma_f32_16x16x32_bf16 v[124:127], v[236:239], v[60:63], v[124:127]
s_waitcnt lgkmcnt(6)
v_mfma_f32_16x16x32_bf16 v[64:67], v[128:131], v[160:163], v[64:67]
s_add_u32 s78, s75, 0x8000
v_add_u32 v8, s78, v7
s_waitcnt lgkmcnt(4)
v_mfma_f32_16x16x32_bf16 v[80:83], v[132:135], v[160:163], v[80:83]
v_xor_b32 v9, 32, v8
v_xor_b32 v10, 64, v8
s_waitcnt lgkmcnt(2)
v_mfma_f32_16x16x32_bf16 v[96:99], v[136:139], v[160:163], v[96:99]
v_xor_b32 v11, 0x60, v8
ds_read_b64_tr_b16 v[240:241], v8
s_waitcnt lgkmcnt(1)
v_mfma_f32_16x16x32_bf16 v[112:115], v[140:143], v[160:163], v[112:115]
ds_read_b64_tr_b16 v[242:243], v8 offset:256
ds_read_b64_tr_b16 v[244:245], v9
v_mfma_f32_16x16x32_bf16 v[68:71], v[128:131], v[164:167], v[68:71]
ds_read_b64_tr_b16 v[246:247], v9 offset:256
ds_read_b64_tr_b16 v[248:249], v10
v_mfma_f32_16x16x32_bf16 v[84:87], v[132:135], v[164:167], v[84:87]
ds_read_b64_tr_b16 v[250:251], v10 offset:256
ds_read_b64_tr_b16 v[252:253], v11
v_mfma_f32_16x16x32_bf16 v[100:103], v[136:139], v[164:167], v[100:103]
ds_read_b64_tr_b16 v[254:255], v11 offset:256
s_waitcnt vmcnt(7)
v_max3_u32 v13, v16, v17, v18
v_mfma_f32_16x16x32_bf16 v[116:119], v[140:143], v[164:167], v[116:119]
s_waitcnt vmcnt(6)
v_max3_u32 v13, v13, v19, v20
v_max3_u32 v13, v13, v21, v22
v_mfma_f32_16x16x32_bf16 v[72:75], v[128:131], v[168:171], v[72:75]
s_waitcnt vmcnt(5)
v_max3_u32 v13, v13, v23, v24
v_max3_u32 v13, v13, v25, v26
v_mfma_f32_16x16x32_bf16 v[88:91], v[132:135], v[168:171], v[88:91]
s_waitcnt vmcnt(4)
v_max3_u32 v13, v13, v27, v28
v_max3_u32 v13, v13, v29, v30
v_mfma_f32_16x16x32_bf16 v[104:107], v[136:139], v[168:171], v[104:107]
v_max_u32 v13, v13, v31
v_cmp_eq_u32 vcc, -1, v13
s_nop 0
s_cbranch_vccz L_hk16_ok
s_mov_b32 s59, 0x10000
s_add_u32 s78, s84, 0x10000
L_hk16_spin:
s_add_u32 s9, s78, s63
buffer_load_dwordx4 v[16:19], v1, s[44:47], s9 offen sc1
s_add_u32 s9, s78, s64
buffer_load_dwordx4 v[20:23], v1, s[44:47], s9 offen sc1
s_add_u32 s9, s78, s65
buffer_load_dwordx4 v[24:27], v1, s[44:47], s9 offen sc1
s_add_u32 s9, s78, s66
buffer_load_dwordx4 v[28:31], v1, s[44:47], s9 offen sc1
s_waitcnt vmcnt(0)
v_max3_u32 v13, v16, v17, v18
v_max3_u32 v13, v13, v19, v20
v_max3_u32 v13, v13, v21, v22
v_max3_u32 v13, v13, v23, v24
v_max3_u32 v13, v13, v25, v26
v_max3_u32 v13, v13, v27, v28
v_max3_u32 v13, v13, v29, v30
v_max_u32 v13, v13, v31
v_cmp_eq_u32 vcc, -1, v13
s_sub_u32 s59, s59, 1
s_cbranch_scc1 L_hk16_ok
s_cbranch_vccnz L_hk16_spin
L_hk16_ok:
v_mfma_f32_16x16x32_bf16 v[120:123], v[140:143], v[168:171], v[120:123]
v_mfma_f32_16x16x32_bf16 v[76:79], v[128:131], v[172:175], v[76:79]
v_mfma_f32_16x16x32_bf16 v[92:95], v[132:135], v[172:175], v[92:95]
v_mfma_f32_16x16x32_bf16 v[108:111], v[136:139], v[172:175], v[108:111]
v_mfma_f32_16x16x32_bf16 v[124:127], v[140:143], v[172:175], v[124:127]
s_waitcnt lgkmcnt(6)
v_mfma_f32_16x16x32_bf16 v[64:67], v[240:243], v[16:19], v[64:67]
s_add_u32 s78, s62, 0x1000
v_add_u32 v8, s78, v7
s_waitcnt lgkmcnt(4)
v_mfma_f32_16x16x32_bf16 v[80:83], v[244:247], v[16:19], v[80:83]
v_xor_b32 v9, 32, v8
v_xor_b32 v10, 64, v8
s_waitcnt lgkmcnt(2)
v_mfma_f32_16x16x32_bf16 v[96:99], v[248:251], v[16:19], v[96:99]
v_xor_b32 v11, 0x60, v8
ds_read_b64_tr_b16 v[32:33], v8
s_waitcnt lgkmcnt(1)
v_mfma_f32_16x16x32_bf16 v[112:115], v[252:255], v[16:19], v[112:115]
ds_read_b64_tr_b16 v[34:35], v8 offset:256
ds_read_b64_tr_b16 v[36:37], v9
v_mfma_f32_16x16x32_bf16 v[68:71], v[240:243], v[20:23], v[68:71]
ds_read_b64_tr_b16 v[38:39], v9 offset:256
ds_read_b64_tr_b16 v[40:41], v10
v_mfma_f32_16x16x32_bf16 v[84:87], v[244:247], v[20:23], v[84:87]
ds_read_b64_tr_b16 v[42:43], v10 offset:256
ds_read_b64_tr_b16 v[44:45], v11
v_mfma_f32_16x16x32_bf16 v[100:103], v[248:251], v[20:23], v[100:103]
ds_read_b64_tr_b16 v[46:47], v11 offset:256
s_waitcnt vmcnt(3)
v_max3_u32 v13, v176, v177, v178
v_mfma_f32_16x16x32_bf16 v[116:119], v[252:255], v[20:23], v[116:119]
s_waitcnt vmcnt(2)
v_max3_u32 v13, v13, v179, v180
v_max3_u32 v13, v13, v181, v182
v_mfma_f32_16x16x32_bf16 v[72:75], v[240:243], v[24:27], v[72:75]
s_waitcnt vmcnt(1)
v_max3_u32 v13, v13, v183, v184
v_max3_u32 v13, v13, v185, v186
v_mfma_f32_16x16x32_bf16 v[88:91], v[244:247], v[24:27], v[88:91]
s_waitcnt vmcnt(0)
v_max3_u32 v13, v13, v187, v188
v_max3_u32 v13, v13, v189, v190
v_mfma_f32_16x16x32_bf16 v[104:107], v[248:251], v[24:27], v[104:107]
v_max_u32 v13, v13, v191
v_cmp_eq_u32 vcc, -1, v13
s_nop 0
s_cbranch_vccz L_hk17_ok
s_mov_b32 s59, 0x10000
s_add_u32 s78, s85, 0x10000
L_hk17_spin:
s_add_u32 s9, s78, s63
buffer_load_dwordx4 v[176:179], v1, s[44:47], s9 offen sc1
s_add_u32 s9, s78, s64
buffer_load_dwordx4 v[180:183], v1, s[44:47], s9 offen sc1
s_add_u32 s9, s78, s65
buffer_load_dwordx4 v[184:187], v1, s[44:47], s9 offen sc1
s_add_u32 s9, s78, s66
buffer_load_dwordx4 v[188:191], v1, s[44:47], s9 offen sc1
s_waitcnt vmcnt(0)
v_max3_u32 v13, v176, v177, v178
v_max3_u32 v13, v13, v179, v180
v_max3_u32 v13, v13, v181, v182
v_max3_u32 v13, v13, v183, v184
v_max3_u32 v13, v13, v185, v186
v_max3_u32 v13, v13, v187, v188
v_max3_u32 v13, v13, v189, v190
v_max_u32 v13, v13, v191
v_cmp_eq_u32 vcc, -1, v13
s_sub_u32 s59, s59, 1
s_cbranch_scc1 L_hk17_ok
s_cbranch_vccnz L_hk17_spin
L_hk17_ok:
v_mfma_f32_16x16x32_bf16 v[120:123], v[252:255], v[24:27], v[120:123]
v_mfma_f32_16x16x32_bf16 v[76:79], v[240:243], v[28:31], v[76:79]
v_mfma_f32_16x16x32_bf16 v[92:95], v[244:247], v[28:31], v[92:95]
v_mfma_f32_16x16x32_bf16 v[108:111], v[248:251], v[28:31], v[108:111]
v_mfma_f32_16x16x32_bf16 v[124:127], v[252:255], v[28:31], v[124:127]
v_add_u32 v8, s62, v1
s_waitcnt lgkmcnt(6)
v_mfma_f32_16x16x32_bf16 v[68:71], v[32:35], v[180:183], v[68:71]
s_waitcnt lgkmcnt(4)
v_mfma_f32_16x16x32_bf16 v[84:87], v[36:39], v[180:183], v[84:87]
s_waitcnt lgkmcnt(2)
v_mfma_f32_16x16x32_bf16 v[100:103], v[40:43], v[180:183], v[100:103]
s_waitcnt lgkmcnt(0)
v_mfma_f32_16x16x32_bf16 v[116:119], v[44:47], v[180:183], v[116:119]
v_mfma_f32_16x16x32_bf16 v[72:75], v[32:35], v[184:187], v[72:75]
v_mfma_f32_16x16x32_bf16 v[88:91], v[36:39], v[184:187], v[88:91]
v_mfma_f32_16x16x32_bf16 v[104:107], v[40:43], v[184:187], v[104:107]
v_mfma_f32_16x16x32_bf16 v[120:123], v[44:47], v[184:187], v[120:123]
v_mfma_f32_16x16x32_bf16 v[76:79], v[32:35], v[188:191], v[76:79]
ds_write_b128 v8, v[68:71] offset:4096
v_mfma_f32_16x16x32_bf16 v[92:95], v[36:39], v[188:191], v[92:95]
ds_write_b128 v8, v[84:87] offset:5120
v_mfma_f32_16x16x32_bf16 v[108:111], v[40:43], v[188:191], v[108:111]
ds_write_b128 v8, v[100:103] offset:6144
v_mfma_f32_16x16x32_bf16 v[124:127], v[44:47], v[188:191], v[124:127]
ds_write_b128 v8, v[116:119] offset:7168
v_mfma_f32_16x16x32_bf16 v[64:67], v[32:35], v[176:179], v[64:67]
ds_write_b128 v8, v[72:75] offset:8192
v_mfma_f32_16x16x32_bf16 v[80:83], v[36:39], v[176:179], v[80:83]
ds_write_b128 v8, v[88:91] offset:9216
v_mfma_f32_16x16x32_bf16 v[96:99], v[40:43], v[176:179], v[96:99]
ds_write_b128 v8, v[104:107] offset:10240
v_mfma_f32_16x16x32_bf16 v[112:115], v[44:47], v[176:179], v[112:115]
ds_write_b128 v8, v[120:123] offset:11264
ds_write_b128 v8, v[76:79] offset:12288
ds_write_b128 v8, v[92:95] offset:13312
ds_write_b128 v8, v[108:111] offset:14336
ds_write_b128 v8, v[124:127] offset:15360
s_sub_u32 s9, s4, 1
s_and_b32 s9, s9, 3
s_lshl_b32 s9, s9, 14
v_add_u32 v9, s9, v1
s_sub_u32 s9, s4, 2
s_and_b32 s9, s9, 3
s_lshl_b32 s9, s9, 14
v_add_u32 v10, s9, v1
s_sub_u32 s9, s4, 3
s_and_b32 s9, s9, 3
s_lshl_b32 s9, s9, 14
v_add_u32 v11, s9, v1
v_and_b32 v32, 15, v0
v_lshlrev_b32 v32, 10, v32
v_bfe_u32 v33, v0, 4, 1
v_lshlrev_b32 v33, 5, v33
v_add_u32 v32, v32, v33
v_lshrrev_b32 v33, 5, v0
v_lshlrev_b32 v33, 4, v33
v_add_u32 v32, v32, v33
s_lshl_b32 s11, s7, 2
s_add_u32 s11, s11, s4
s_lshl_b32 s11, s11, 14
s_lshl_b32 s10, s8, 7
s_add_u32 s11, s11, s10
v_bfe_u32 v33, v0, 3, 1
v_mul_u32_u24 v33, 0x1fc0, v33
v_sub_u32 v32, v32, v33
s_add_u32 s10, s11, 0x2000
s_waitcnt lgkmcnt(0)
s_barrier
ds_read_b128 v[144:147], v9 offset:4096
ds_read_b128 v[160:163], v10 offset:8192
ds_read_b128 v[176:179], v11 offset:12288
ds_read_b128 v[148:151], v9 offset:5120
ds_read_b128 v[164:167], v10 offset:9216
ds_read_b128 v[180:183], v11 offset:13312
ds_read_b128 v[152:155], v9 offset:6144
ds_read_b128 v[168:171], v10 offset:10240
ds_read_b128 v[184:187], v11 offset:14336
ds_read_b128 v[156:159], v9 offset:7168
ds_read_b128 v[172:175], v10 offset:11264
ds_read_b128 v[188:191], v11 offset:15360
s_waitcnt lgkmcnt(11)
v_add_f32 v64, v64, v144
v_add_f32 v65, v65, v145
v_add_f32 v66, v66, v146
v_add_f32 v67, v67, v147
s_waitcnt lgkmcnt(9)
v_add_f32 v160, v160, v176
v_add_f32 v161, v161, v177
v_add_f32 v162, v162, v178
v_add_f32 v163, v163, v179
v_add_f32 v64, v64, v160
v_add_f32 v65, v65, v161
v_add_f32 v66, v66, v162
v_add_f32 v67, v67, v163
s_waitcnt lgkmcnt(8)
v_add_f32 v80, v80, v148
v_add_f32 v81, v81, v149
v_add_f32 v82, v82, v150
v_add_f32 v83, v83, v151
s_waitcnt lgkmcnt(6)
v_add_f32 v164, v164, v180
v_add_f32 v165, v165, v181
v_add_f32 v166, v166, v182
v_add_f32 v167, v167, v183
v_add_f32 v80, v80, v164
v_add_f32 v81, v81, v165
v_add_f32 v82, v82, v166
v_add_f32 v83, v83, v167
v_cvt_pk_bf16_f32 v16, v64, v65
v_cvt_pk_bf16_f32 v17, v66, v67
v_cvt_pk_bf16_f32 v18, v80, v81
v_cvt_pk_bf16_f32 v19, v82, v83
s_nop 0
v_permlane16_swap_b32 v16, v18
v_permlane16_swap_b32 v17, v19
s_waitcnt lgkmcnt(5)
v_add_f32 v96, v96, v152
v_add_f32 v97, v97, v153
v_add_f32 v98, v98, v154
v_add_f32 v99, v99, v155
s_waitcnt lgkmcnt(3)
v_add_f32 v168, v168, v184
v_add_f32 v169, v169, v185
v_add_f32 v170, v170, v186
v_add_f32 v171, v171, v187
v_add_f32 v96, v96, v168
v_add_f32 v97, v97, v169
v_add_f32 v98, v98, v170
v_add_f32 v99, v99, v171
s_waitcnt lgkmcnt(2)
v_add_f32 v112, v112, v156
v_add_f32 v113, v113, v157
v_add_f32 v114, v114, v158
v_add_f32 v115, v115, v159
s_waitcnt lgkmcnt(0)
v_add_f32 v172, v172, v188
v_add_f32 v173, v173, v189
v_add_f32 v174, v174, v190
v_add_f32 v175, v175, v191
v_add_f32 v112, v112, v172
v_add_f32 v113, v113, v173
v_add_f32 v114, v114, v174
v_add_f32 v115, v115, v175
v_cvt_pk_bf16_f32 v20, v96, v97
v_cvt_pk_bf16_f32 v21, v98, v99
v_cvt_pk_bf16_f32 v22, v112, v113
v_cvt_pk_bf16_f32 v23, v114, v115
s_nop 0
v_permlane16_swap_b32 v20, v22
v_permlane16_swap_b32 v21, v23
v_mov_b32 v24, v16
v_mov_b32 v25, v17
v_mov_b32 v26, v18
v_mov_b32 v27, v19
v_mov_b32_dpp v16, v20 row_ror:8 row_mask:0xf bank_mask:0xc
v_mov_b32_dpp v17, v21 row_ror:8 row_mask:0xf bank_mask:0xc
v_mov_b32_dpp v18, v22 row_ror:8 row_mask:0xf bank_mask:0xc
v_mov_b32_dpp v19, v23 row_ror:8 row_mask:0xf bank_mask:0xc
v_mov_b32_dpp v20, v24 row_ror:8 row_mask:0xf bank_mask:0x3
v_mov_b32_dpp v21, v25 row_ror:8 row_mask:0xf bank_mask:0x3
v_mov_b32_dpp v22, v26 row_ror:8 row_mask:0xf bank_mask:0x3
v_mov_b32_dpp v23, v27 row_ror:8 row_mask:0xf bank_mask:0x3
buffer_store_dwordx4 v[16:19], v32, s[48:51], s11 offen sc1
buffer_store_dwordx4 v[20:23], v32, s[48:51], s10 offen sc1
s_endpgm
L_end:
s_endpgm
.section .rodata,"a"
.p2align 6
.amdhsa_kernel gated_mix__linear_kernel_hedgehog__glu_gated_swiglu__prompt_kernel
  .amdhsa_next_free_vgpr 256
  .amdhsa_next_free_sgpr 102
  .amdhsa_accum_offset 256
  .amdhsa_group_segment_fixed_size 0
  .amdhsa_kernarg_size 96
  .amdhsa_user_sgpr_count 2
  .amdhsa_user_sgpr_kernarg_segment_ptr 1
  .amdhsa_system_sgpr_workgroup_id_x 1
  .amdhsa_float_denorm_mode_32 3
.end_amdhsa_kernel
```
